```python
import torch

def _softmax(x, axis=-1):
    return torch.softmax(x, dim=axis)
def _gelu(x):
    return torch.nn.functional.gelu(x, approximate="tanh")
def _silu(x):
    return torch.nn.functional.silu(x)
def _sigmoid(x):
    return torch.sigmoid(x)
def _layernorm(x, axis=-1, eps=1e-5):
    m = x.mean(dim=axis, keepdim=True)
    v = x.var(dim=axis, keepdim=True, unbiased=False)
    return (x - m) / torch.sqrt(v + eps)
def _scatter_add(tgt, idx, src, axis=0):
    return tgt.clone().index_add_(axis, idx, src)
def _segment_sum(src, seg, n):
    out = torch.zeros((n,) + src.shape[1:], dtype=src.dtype)
    return out.index_add_(0, seg, src)
def _pad(x, pw):
    flat = tuple(v for pair in reversed(pw) for v in pair)
    return torch.nn.functional.pad(x, flat)

kernel_name = 'standalone__window_attn_swin_v2__vision'

def setup_inputs():

    _w = (lambda a: (lambda t: t.to(torch.bfloat16) if t.is_floating_point() else t)(torch.as_tensor(a)))
    win = 8
    H = W = (224 // win) * win
    C = 96
    nh = 4
    shift = win // 2
    coords = torch.stack(torch.meshgrid(torch.arange(win), torch.arange(win), indexing="ij"), -1).reshape(-1, 2)
    rel = coords[:, None, :] - coords[None, :, :]
    rel_idx = ((rel[..., 0] + win - 1) * (2 * win - 1) + (rel[..., 1] + win - 1)).to(torch.int64)
    tab = torch.stack(torch.meshgrid(torch.arange(1 - win, win), torch.arange(1 - win, win), indexing="ij"), -1).reshape(-1, 2).to(float)
    tab = (lambda _x: torch.sign(torch.as_tensor(_x)))(tab) * (lambda _x: torch.log1p(torch.as_tensor(_x)))(torch.abs(tab))
    img = torch.zeros((H, W), dtype=torch.int64)
    cnt = 0
    for hs in (slice(0, H - win), slice(H - win, H - shift), slice(H - shift, H)):
        for ws in (slice(0, W - win), slice(W - win, W - shift), slice(W - shift, W)):
            img[hs, ws] = cnt; cnt += 1
    mw = img.reshape(H // win, win, W // win, win).permute(0, 2, 1, 3).reshape(-1, win * win)
    mask = (mw[:, :, None] != mw[:, None, :]).to(float) * (-100.0)
    return {
        "x": _w((lambda *s: torch.randn(*s, dtype=torch.bfloat16) * 0.05)(1, H, W, C)),
        "wqkv": _w((lambda *s: torch.randn(*s, dtype=torch.bfloat16) * 1.6)(C, 3 * C)),
        "wo": _w((lambda *s: torch.randn(*s, dtype=torch.bfloat16) * 0.05)(C, C)),
        "logit_scale": _w((lambda *s: torch.randn(*s, dtype=torch.bfloat16) * 1.6)(nh)),
        "cpb_w1": _w((lambda *s: torch.randn(*s, dtype=torch.bfloat16) * 0.8)(2, 4 * nh)),
        "cpb_w2": _w((lambda *s: torch.randn(*s, dtype=torch.bfloat16) * 0.8)(4 * nh, nh)),
        "rel_coords": _w(tab),
        "rel_idx": _w(rel_idx),
        "attn_mask": _w(mask),
    }

def reference(x, wqkv, wo, logit_scale, cpb_w1, cpb_w2, rel_coords, rel_idx, attn_mask):
    B, H, W, C = x.shape
    win = 8
    nh = 4
    hd = C // nh
    shift = win // 2
    ww = win * win
    nH, nW = H // win, W // win
    xs = torch.roll(x, (-shift, -shift), (1, 2))
    xw = (lambda x, *d: x.permute(*d))(xs.reshape(B, nH, win, nW, win, C), 0, 1, 3, 2, 4, 5).reshape(B * nH * nW, ww, C)
    qkv = (lambda x, *d: x.permute(*d))((xw @ wqkv).reshape(B * nH * nW, ww, 3, nh, hd), 2, 0, 3, 1, 4)
    q, k, v = qkv[0], qkv[1], qkv[2]
    qn = q * (torch.einsum("bhqd,bhqd->bhq", q, q)[..., None] + 1e-12) ** -0.5
    kn = k * (torch.einsum("bhkd,bhkd->bhk", k, k)[..., None] + 1e-12) ** -0.5
    logits = torch.einsum("bhqd,bhkd->bhqk", qn, kn)
    tau = torch.exp(torch.clip(logit_scale, -100.0, 4.6052))
    logits = logits * tau[None, :, None, None]
    hcpb = rel_coords @ cpb_w1
    hcpb = torch.where(hcpb > 0, hcpb, hcpb * 0)
    bias_tab = 16.0 * _sigmoid(hcpb @ cpb_w2)
    bias = (lambda x, *d: x.permute(*d))(bias_tab[rel_idx], 2, 0, 1)
    logits = logits.reshape(B, nH * nW, nh, ww, ww) + bias[None, None, :, :, :] + attn_mask[None, :, None, :, :]
    p = _softmax(logits.reshape(B * nH * nW, nh, ww, ww), axis=-1)
    o = (lambda x, *d: x.permute(*d))(torch.einsum("bhqk,bhkd->bhqd", p, v), 0, 2, 1, 3).reshape(B * nH * nW, ww, C) @ wo
    o = (lambda x, *d: x.permute(*d))(o.reshape(B, nH, nW, win, win, C), 0, 1, 3, 2, 4, 5).reshape(B, H, W, C)
    o = torch.roll(o, (shift, shift), (1, 2))
    return _layernorm(o, axis=-1)
```

```asm
; @launch grid=(256,1,1) block=(512,1,1) lds=139776
.amdgcn_target "amdgcn-amd-amdhsa--gfx950"
.text
.globl standalone__window_attn_swin_v2__vision_kernel
.p2align 8
.type standalone__window_attn_swin_v2__vision_kernel,@function
standalone__window_attn_swin_v2__vision_kernel:
    s_cmp_ge_u32 s2, 256
    s_cbranch_scc1 L_end
    s_load_dwordx16 s[40:55], s[0:1], 0
    s_load_dwordx2 s[56:57], s[0:1], 72
    s_getpc_b64 s[6:7]
L_pc:
    v_lshlrev_b32 v12, 7, v0
    v_min_u32 v12, L_fastend-L_pc-4, v12
    global_load_dword v253, v12, s[6:7]
    v_lshrrev_b32 v11, 6, v0
    v_and_b32 v254, 63, v0
    v_readfirstlane_b32 s58, v11
    v_lshlrev_b32 v194, 4, v254
    v_and_b32 v190, 15, v254
    v_lshrrev_b32 v191, 4, v254
    s_nop 0
    s_lshr_b32 s59, s58, 2
    s_and_b32 s60, s58, 3
    v_lshlrev_b32 v198, 1, v191
    s_mul_i32 s81, s60, 86016
    s_add_u32 s81, s81, 172800
    s_cmp_ge_u32 s60, 2
    s_cselect_b32 s93, 9633792, 0
    s_lshl_b32 s73, s59, 8
    s_add_u32 s61, s2, s73
    s_mul_hi_u32 s73, s61, 153391690
    s_mul_i32 s74, s73, 28
    s_sub_u32 s74, s61, s74
    s_mul_i32 s75, s73, 344064
    s_mul_i32 s78, s74, 1536
    s_add_u32 s63, s75, s78
    s_add_u32 s63, s63, s81
    s_cmp_eq_u32 s74, 27
    s_cselect_b32 s65, -1, 0
    s_cmp_eq_u32 s73, 27
    s_cselect_b32 s67, 1, 0
    s_cselect_b32 s73, s93, 0
    s_sub_u32 s63, s63, s73
    s_add_u32 s24, s2, 256
    s_mul_hi_u32 s73, s24, 153391690
    s_mul_i32 s74, s73, 28
    s_sub_u32 s74, s24, s74
    s_mul_i32 s75, s73, 344064
    s_mul_i32 s78, s74, 1536
    s_add_u32 s25, s75, s78
    s_add_u32 s25, s25, s81
    s_cmp_eq_u32 s74, 27
    s_cselect_b32 s26, -1, 0
    s_cmp_eq_u32 s73, 27
    s_cselect_b32 s27, 1, 0
    s_cselect_b32 s73, s93, 0
    s_sub_u32 s25, s25, s73
    s_mov_b32 s75, 41472
    v_mul_u32_u24 v12, 1366, v254
    v_lshrrev_b32 v250, 16, v12
    v_xor_b32 v13, v254, v250
    v_lshlrev_b32 v13, 4, v13
    v_lshrrev_b32 v14, 1, v250
    v_mad_u32_u24 v184, v14, s75, v13
    v_add_u32 v11, 64, v254
    v_mul_u32_u24 v12, 1366, v11
    v_lshrrev_b32 v251, 16, v12
    v_xor_b32 v13, v11, v251
    v_lshlrev_b32 v13, 4, v13
    v_lshrrev_b32 v14, 1, v251
    v_mad_u32_u24 v185, v14, s75, v13
    v_add_u32 v11, 128, v254
    v_mul_u32_u24 v12, 1366, v11
    v_lshrrev_b32 v252, 16, v12
    v_xor_b32 v13, v11, v252
    v_lshlrev_b32 v13, 4, v13
    v_lshrrev_b32 v14, 1, v252
    v_mad_u32_u24 v186, v14, s75, v13
    s_cmp_eq_u32 s59, 0
    s_cbranch_scc1 L_nopp
    s_setprio 3
L_nopp:
    s_waitcnt lgkmcnt(0)
    s_cmp_lg_u32 s59, 0
    s_cbranch_scc1 L_p_g1
    global_load_ushort v201, v198, s[46:47]
    s_mov_b32 s12, s42
    s_and_b32 s13, s43, 0xffff
    s_mov_b32 s14, 55296
    s_mov_b32 s15, 0x00020000
    s_lshr_b32 s78, s2, 3
    s_and_b32 s78, s78, 7
    s_lshl_b32 s78, s78, 2
    s_add_u32 s78, s78, s60
    s_lshl_b32 m0, s78, 10
    s_mov_b32 s8, s40
    s_and_b32 s9, s41, 0xffff
    s_mov_b32 s10, 9633792
    s_mov_b32 s11, 0x00020000
    buffer_load_dwordx4 v194, s[12:15], m0 offen lds
    s_add_u32 m0, m0, 4096
    s_cmp_ge_u32 m0, 57344
    s_cselect_b32 s78, 57344, 0
    s_sub_u32 m0, m0, s78
    s_nop 0
    buffer_load_dwordx4 v194, s[12:15], m0 offen lds
    s_add_u32 m0, m0, 4096
    s_cmp_ge_u32 m0, 57344
    s_cselect_b32 s78, 57344, 0
    s_sub_u32 m0, m0, s78
    s_nop 0
    buffer_load_dwordx4 v194, s[12:15], m0 offen lds
    s_add_u32 m0, m0, 4096
    s_cmp_ge_u32 m0, 57344
    s_cselect_b32 s78, 57344, 0
    s_sub_u32 m0, m0, s78
    s_nop 0
    buffer_load_dwordx4 v194, s[12:15], m0 offen lds
    s_add_u32 m0, m0, 4096
    s_cmp_ge_u32 m0, 57344
    s_cselect_b32 s78, 57344, 0
    s_sub_u32 m0, m0, s78
    s_nop 0
    buffer_load_dwordx4 v194, s[12:15], m0 offen lds
    s_add_u32 m0, m0, 4096
    s_cmp_ge_u32 m0, 57344
    s_cselect_b32 s78, 57344, 0
    s_sub_u32 m0, m0, s78
    s_nop 0
    buffer_load_dwordx4 v194, s[12:15], m0 offen lds
    s_add_u32 m0, m0, 4096
    s_cmp_ge_u32 m0, 57344
    s_cselect_b32 s78, 57344, 0
    s_sub_u32 m0, m0, s78
    s_nop 0
    buffer_load_dwordx4 v194, s[12:15], m0 offen lds
    s_add_u32 m0, m0, 4096
    s_cmp_ge_u32 m0, 57344
    s_cselect_b32 s78, 57344, 0
    s_sub_u32 m0, m0, s78
    s_nop 0
    buffer_load_dwordx4 v194, s[12:15], m0 offen lds
    s_add_u32 m0, m0, 4096
    s_cmp_ge_u32 m0, 57344
    s_cselect_b32 s78, 57344, 0
    s_sub_u32 m0, m0, s78
    s_nop 0
    buffer_load_dwordx4 v194, s[12:15], m0 offen lds
    s_add_u32 m0, m0, 4096
    s_cmp_ge_u32 m0, 57344
    s_cselect_b32 s78, 57344, 0
    s_sub_u32 m0, m0, s78
    s_nop 0
    buffer_load_dwordx4 v194, s[12:15], m0 offen lds
    s_add_u32 m0, m0, 4096
    s_cmp_ge_u32 m0, 57344
    s_cselect_b32 s78, 57344, 0
    s_sub_u32 m0, m0, s78
    s_nop 0
    buffer_load_dwordx4 v194, s[12:15], m0 offen lds
    s_add_u32 m0, m0, 4096
    s_cmp_ge_u32 m0, 57344
    s_cselect_b32 s78, 57344, 0
    s_sub_u32 m0, m0, s78
    s_nop 0
    buffer_load_dwordx4 v194, s[12:15], m0 offen lds
    s_add_u32 m0, m0, 4096
    s_cmp_ge_u32 m0, 57344
    s_cselect_b32 s78, 57344, 0
    s_sub_u32 m0, m0, s78
    s_nop 0
    buffer_load_dwordx4 v194, s[12:15], m0 offen lds
    s_add_u32 m0, m0, 4096
    s_cmp_ge_u32 m0, 57344
    s_cselect_b32 s78, 57344, 0
    s_sub_u32 m0, m0, s78
    s_nop 0
    buffer_load_dwordx4 v194, s[12:15], m0 offen lds
    s_mul_i32 s73, s60, 3072
    s_cmp_lg_u32 s65, 0
    s_cbranch_scc1 L_xd0_w
    s_add_u32 m0, s73, 79872
    s_nop 0
    buffer_load_dwordx4 v184, s[8:11], s63 offen nt lds
    s_add_u32 m0, s73, 80896
    s_nop 0
    buffer_load_dwordx4 v185, s[8:11], s63 offen nt lds
    s_add_u32 m0, s73, 81920
    s_nop 0
    buffer_load_dwordx4 v186, s[8:11], s63 offen nt lds
    s_branch L_xd0_d
L_xd0_w:
    v_and_b32 v11, 1, v250
    v_mul_u32_u24 v11, 43008, v11
    v_add_u32 v12, s63, v184
    v_sub_u32 v12, v12, v11
    s_add_u32 m0, s73, 79872
    s_nop 0
    buffer_load_dwordx4 v12, s[8:11], 0 offen nt lds
    v_and_b32 v11, 1, v251
    v_mul_u32_u24 v11, 43008, v11
    v_add_u32 v12, s63, v185
    v_sub_u32 v12, v12, v11
    s_add_u32 m0, s73, 80896
    s_nop 0
    buffer_load_dwordx4 v12, s[8:11], 0 offen nt lds
    v_and_b32 v11, 1, v252
    v_mul_u32_u24 v11, 43008, v11
    v_add_u32 v12, s63, v186
    v_sub_u32 v12, v12, v11
    s_add_u32 m0, s73, 81920
    s_nop 0
    buffer_load_dwordx4 v12, s[8:11], 0 offen nt lds
L_xd0_d:
    s_mul_i32 s73, s60, 3072
    s_cmp_lg_u32 s26, 0
    s_cbranch_scc1 L_xd1_w
    s_add_u32 m0, s73, 92160
    s_nop 0
    buffer_load_dwordx4 v184, s[8:11], s25 offen nt lds
    s_add_u32 m0, s73, 93184
    s_nop 0
    buffer_load_dwordx4 v185, s[8:11], s25 offen nt lds
    s_add_u32 m0, s73, 94208
    s_nop 0
    buffer_load_dwordx4 v186, s[8:11], s25 offen nt lds
    s_branch L_xd1_d
L_xd1_w:
    v_and_b32 v11, 1, v250
    v_mul_u32_u24 v11, 43008, v11
    v_add_u32 v12, s25, v184
    v_sub_u32 v12, v12, v11
    s_add_u32 m0, s73, 92160
    s_nop 0
    buffer_load_dwordx4 v12, s[8:11], 0 offen nt lds
    v_and_b32 v11, 1, v251
    v_mul_u32_u24 v11, 43008, v11
    v_add_u32 v12, s25, v185
    v_sub_u32 v12, v12, v11
    s_add_u32 m0, s73, 93184
    s_nop 0
    buffer_load_dwordx4 v12, s[8:11], 0 offen nt lds
    v_and_b32 v11, 1, v252
    v_mul_u32_u24 v11, 43008, v11
    v_add_u32 v12, s25, v186
    v_sub_u32 v12, v12, v11
    s_add_u32 m0, s73, 94208
    s_nop 0
    buffer_load_dwordx4 v12, s[8:11], 0 offen nt lds
L_xd1_d:
    s_branch L_p_join
L_p_g1:
    s_waitcnt vmcnt(20)
    global_load_ushort v201, v198, s[46:47]
    s_mov_b32 s12, s48
    s_and_b32 s13, s49, 0xffff
    s_mov_b32 s14, 64
    s_mov_b32 s15, 0x00020000
    s_mov_b32 m0, 68608
    s_mov_b64 exec, 0xf
    buffer_load_dwordx4 v194, s[12:15], 0 offen lds
    s_mov_b32 s12, s50
    s_and_b32 s13, s51, 0xffff
    s_mov_b32 s14, 128
    s_mov_b32 s15, 0x00020000
    s_mov_b32 m0, 69632
    s_mov_b64 exec, 0xff
    buffer_load_dwordx4 v194, s[12:15], 0 offen lds
    s_mov_b32 s12, s52
    s_and_b32 s13, s53, 0xffff
    s_mov_b32 s14, 900
    s_mov_b32 s15, 0x00020000
    s_mov_b32 m0, 70656
    s_mov_b64 exec, -1
    buffer_load_dwordx4 v194, s[12:15], 0 offen lds
    s_mov_b64 exec, -1
    s_setprio 0
    s_mov_b32 s8, s40
    s_and_b32 s9, s41, 0xffff
    s_mov_b32 s10, 9633792
    s_mov_b32 s11, 0x00020000
    s_lshl_b32 s73, s60, 4
    v_add_u32 v200, s73, v190
    s_mov_b32 s73, 70656
    v_lshl_add_u32 v195, v200, 2, s73
    s_mov_b32 s73, 68608
    v_lshl_add_u32 v196, v190, 1, s73
    v_lshrrev_b32 v14, 2, v190
    v_lshlrev_b32 v14, 1, v14
    v_lshl_add_u32 v197, v191, 5, v14
    v_add_u32 v197, 69632, v197
    v_mov_b32 v204, 0
    v_mov_b32 v205, 0
    v_mov_b32 v206, 0
    v_mov_b32 v207, 0
    v_mov_b32 v208, 0
    v_mov_b32 v209, 0
    v_mov_b32 v210, 0
    v_mov_b32 v211, 0
    v_mov_b32 v236, 0
    v_mov_b32 v237, 0
    v_mov_b32 v238, 0
    v_mov_b32 v239, 0
    v_mov_b32 v240, 0
    v_mov_b32 v241, 0
    v_mov_b32 v242, 0
    v_mov_b32 v243, 0
    v_mov_b32 v212, 0
    v_mov_b32 v213, 0
    v_mov_b32 v214, 0
    v_mov_b32 v215, 0
    v_mov_b32 v245, 0
    v_mov_b32 v218, 0
    v_mov_b32 v219, 0
    v_mov_b32 v222, 0
    v_mov_b32 v223, 0
    v_mov_b32 v146, 0
    v_mov_b32 v147, 0
    v_mov_b32 v150, 0
    v_mov_b32 v151, 0
    v_mov_b32 v154, 0
    v_mov_b32 v155, 0
    s_mov_b32 s73, 4192
    s_mov_b32 s74, 124
    v_mul_u32_u24 v14, s73, v191
    v_add_u32 v14, 122936, v14
    v_mul_u32_u24 v12, 4370, v200
    v_lshrrev_b32 v12, 16, v12
    v_mad_i32_i24 v13, v200, -4, v14
    v_mad_u32_u24 v156, v12, s74, v13
    v_add_u32 v200, 64, v200
    v_mul_u32_u24 v12, 4370, v200
    v_lshrrev_b32 v12, 16, v12
    v_mad_i32_i24 v13, v200, -4, v14
    v_mad_u32_u24 v157, v12, s74, v13
    v_add_u32 v200, 64, v200
    v_mul_u32_u24 v12, 4370, v200
    v_lshrrev_b32 v12, 16, v12
    v_mad_i32_i24 v13, v200, -4, v14
    v_mad_u32_u24 v158, v12, s74, v13
    v_add_u32 v200, 64, v200
    v_mul_u32_u24 v12, 4370, v200
    v_lshrrev_b32 v12, 16, v12
    v_mad_i32_i24 v13, v200, -4, v14
    v_mad_u32_u24 v159, v12, s74, v13
    v_cmp_gt_u32 vcc, 225, v200
    v_mov_b32 v12, 0x40000000
    s_nop 0
    v_cndmask_b32 v159, v12, v159, vcc
L_p_join:
    s_add_u32 s62, s2, 512
    s_lshr_b32 s73, s2, 1
    s_add_u32 s73, s73, 768
    s_cmp_lt_u32 s2, 32
    s_cselect_b32 s69, 1, 0
    s_cselect_b32 s73, s73, 783
    s_and_b32 s36, s2, 1
    s_cmp_eq_u32 s59, 0
    s_cselect_b32 s62, s62, s73
    s_cselect_b32 s69, 1, s69
    s_cselect_b32 s36, 0, s36
    s_mul_hi_u32 s73, s62, 153391690
    s_mul_i32 s74, s73, 28
    s_sub_u32 s74, s62, s74
    s_mul_i32 s75, s73, 344064
    s_mul_i32 s78, s74, 1536
    s_add_u32 s64, s75, s78
    s_add_u32 s64, s64, s81
    s_cmp_eq_u32 s74, 27
    s_cselect_b32 s66, -1, 0
    s_cmp_eq_u32 s73, 27
    s_cselect_b32 s68, 1, 0
    s_cselect_b32 s73, s93, 0
    s_sub_u32 s64, s64, s73
    s_and_b32 s38, s68, s36
    s_sub_u32 s39, s68, s38
    s_mul_i32 s73, s36, 172032
    s_add_u32 s37, s64, s73
    s_mul_i32 s73, s38, 9633792
    s_sub_u32 s37, s37, s73
    v_and_b32 v11, 1, v250
    v_mul_u32_u24 v11, 43008, v11
    v_and_b32 v11, s66, v11
    v_add_u32 v12, s64, v184
    v_sub_u32 v187, v12, v11
    v_and_b32 v11, 1, v251
    v_mul_u32_u24 v11, 43008, v11
    v_and_b32 v11, s66, v11
    v_add_u32 v12, s64, v185
    v_sub_u32 v188, v12, v11
    v_and_b32 v11, 1, v252
    v_mul_u32_u24 v11, 43008, v11
    v_and_b32 v11, s66, v11
    v_add_u32 v12, s64, v186
    v_sub_u32 v189, v12, v11
    s_lshl_b32 s79, s58, 2
    s_add_u32 s79, s79, 139648
    s_mov_b32 s80, 0x100000
    v_mov_b32 v11, s79
    v_mov_b32 v12, 0
    ds_write_b32 v11, v12
    ds_write_b32 v11, v12 offset:32
    v_and_b32 v192, 31, v254
    v_lshrrev_b32 v193, 5, v254
    v_bfe_u32 v11, v192, 2, 2
    v_xor_b32 v11, v11, v193
    v_lshlrev_b32 v11, 4, v11
    s_mul_i32 s73, s59, 12288
    s_add_u32 s74, s73, 55296
    v_mul_u32_u24 v12, 192, v192
    v_add3_u32 v2, v11, v12, s74
    v_xor_b32 v3, 32, v2
    v_lshrrev_b32 v11, 2, v190
    v_lshl_add_u32 v11, v193, 3, v11
    v_mul_u32_u24 v11, 576, v11
    v_and_b32 v12, 1, v191
    v_lshlrev_b32 v12, 5, v12
    v_and_b32 v13, 3, v254
    v_lshl_add_u32 v12, v13, 3, v12
    s_mul_i32 s73, s60, 48
    v_add3_u32 v104, v11, v12, s73
    s_lshl_b32 s73, s59, 4
    s_add_u32 s73, s73, 139648
    v_lshl_add_u32 v15, v13, 2, s73
    v_mov_b32 v94, 0
    v_mov_b32 v110, 0
    v_mov_b32 v95, 0
    v_mov_b32 v111, 0
    v_mov_b32 v102, 0
    v_mov_b32 v118, 0
    v_mov_b32 v103, 0
    v_mov_b32 v119, 0
    s_mul_i32 s73, s59, 12288
    s_mul_i32 s74, s60, 3072
    s_add_u32 s73, s73, s74
    s_add_u32 s28, s73, 55296
    s_mov_b32 s16, s44
    s_and_b32 s17, s45, 0xffff
    s_mov_b32 s18, 18432
    s_mov_b32 s19, 0x00020000
    s_lshr_b32 s78, s2, 3
    s_and_b32 s78, s78, 7
    s_add_u32 s78, s78, s60
    s_add_u32 s73, s78, 0
    s_cmp_ge_u32 s73, 18
    s_cselect_b32 s74, 18, 0
    s_sub_u32 s73, s73, s74
    s_lshl_b32 s30, s73, 10
    s_add_u32 s73, s78, 4
    s_cmp_ge_u32 s73, 18
    s_cselect_b32 s74, 18, 0
    s_sub_u32 s73, s73, s74
    s_lshl_b32 s31, s73, 10
    s_add_u32 s73, s78, 8
    s_cmp_ge_u32 s73, 18
    s_cselect_b32 s74, 18, 0
    s_sub_u32 s73, s73, s74
    s_lshl_b32 s32, s73, 10
    s_add_u32 s73, s78, 12
    s_cmp_ge_u32 s73, 18
    s_cselect_b32 s74, 18, 0
    s_sub_u32 s73, s73, s74
    s_lshl_b32 s33, s73, 10
    s_add_u32 s73, s78, 16
    s_cmp_ge_u32 s73, 18
    s_cselect_b32 s74, 18, 0
    s_sub_u32 s73, s73, s74
    s_lshl_b32 s34, s73, 10
    s_cmp_lg_u32 s59, 0
    s_cbranch_scc0 L_nogather
    s_waitcnt vmcnt(0)
    s_mov_b64 exec, 0xffff
    ds_read_u16 v212, v196
    ds_read_u16 v245, v196 offset:32
    ds_read_b32 v204, v195 offset:0
    ds_read_b32 v208, v195 offset:256
    ds_read_b32 v236, v195 offset:512
    ds_read_b32 v240, v195 offset:768
    s_mov_b64 exec, -1
    ds_read_u16 v216, v197
    ds_read_u16 v246, v197 offset:8
    ds_read_u16 v217, v197 offset:16
    ds_read_u16 v247, v197 offset:24
L_nogather:
    s_waitcnt vmcnt(20)
    v_lshlrev_b32 v232, 16, v201
    v_max_f32 v232, 0xc2c80000, v232
    v_min_f32 v232, 0x40930000, v232
    v_mul_f32 v232, 0x3fb8aa3b, v232
    v_exp_f32 v232, v232
    s_lshl_b32 s73, s60, 4
    v_cvt_pk_bf16_f32 v232, v232, v232
    v_lshlrev_b32 v232, 16, v232
    s_nop 0
    v_readlane_b32 s70, v232, s73
    s_cmp_lg_u32 s59, 0
    s_cbranch_scc0 L_nomlp
    s_waitcnt lgkmcnt(0)
    v_lshl_or_b32 v212, v245, 16, v212
    v_lshl_or_b32 v216, v246, 16, v216
    v_lshl_or_b32 v217, v247, 16, v217
    v_mfma_f32_16x16x32_bf16 v[224:227], v[212:215], v[204:207], 0
    v_mfma_f32_16x16x32_bf16 v[228:231], v[212:215], v[208:211], 0
    v_mfma_f32_16x16x32_bf16 v[136:139], v[212:215], v[236:239], 0
    v_mfma_f32_16x16x32_bf16 v[140:143], v[212:215], v[240:243], 0
    v_mul_f32 v233, 0xbfb96754, v232
    v_add_f32 v233, 0x4213aae2, v233
    s_mov_b32 s75, 0x41b8aa3b
    v_max_f32 v224, 0, v224
    v_max_f32 v225, 0, v225
    v_max_f32 v226, 0, v226
    v_max_f32 v227, 0, v227
    v_cvt_pk_bf16_f32 v220, v224, v225
    v_cvt_pk_bf16_f32 v221, v226, v227
    v_max_f32 v228, 0, v228
    v_max_f32 v229, 0, v229
    v_max_f32 v230, 0, v230
    v_max_f32 v231, 0, v231
    v_cvt_pk_bf16_f32 v144, v228, v229
    v_cvt_pk_bf16_f32 v145, v230, v231
    v_max_f32 v136, 0, v136
    v_max_f32 v137, 0, v137
    v_max_f32 v138, 0, v138
    v_max_f32 v139, 0, v139
    v_cvt_pk_bf16_f32 v148, v136, v137
    v_cvt_pk_bf16_f32 v149, v138, v139
    v_max_f32 v140, 0, v140
    v_max_f32 v141, 0, v141
    v_max_f32 v142, 0, v142
    v_max_f32 v143, 0, v143
    v_cvt_pk_bf16_f32 v152, v140, v141
    v_cvt_pk_bf16_f32 v153, v142, v143
    v_mfma_f32_16x16x32_bf16 v[224:227], v[216:219], v[220:223], 0
    v_mfma_f32_16x16x32_bf16 v[228:231], v[216:219], v[144:147], 0
    v_mfma_f32_16x16x32_bf16 v[136:139], v[216:219], v[148:151], 0
    v_mfma_f32_16x16x32_bf16 v[140:143], v[216:219], v[152:155], 0
    v_cvt_pk_bf16_f32 v160, v224, v224
    v_cvt_pk_bf16_f32 v161, v228, v228
    s_nop 1
    v_cvt_pk_bf16_f32 v162, v136, v136
    s_nop 2
    v_cvt_pk_bf16_f32 v163, v140, v140
    v_lshlrev_b32 v160, 16, v160
    v_lshlrev_b32 v161, 16, v161
    v_lshlrev_b32 v162, 16, v162
    v_lshlrev_b32 v163, 16, v163
    v_mul_f32 v160, 0xbfb8aa3b, v160
    v_mul_f32 v161, 0xbfb8aa3b, v161
    v_mul_f32 v162, 0xbfb8aa3b, v162
    v_mul_f32 v163, 0xbfb8aa3b, v163
    v_exp_f32 v160, v160
    v_exp_f32 v161, v161
    v_exp_f32 v162, v162
    v_exp_f32 v163, v163
    v_add_f32 v160, 1.0, v160
    v_add_f32 v161, 1.0, v161
    v_add_f32 v162, 1.0, v162
    v_add_f32 v163, 1.0, v163
    v_rcp_f32 v160, v160
    v_rcp_f32 v161, v161
    v_rcp_f32 v162, v162
    v_rcp_f32 v163, v163
    v_cvt_pk_bf16_f32 v160, v160, v160
    v_cvt_pk_bf16_f32 v161, v161, v161
    v_cvt_pk_bf16_f32 v162, v162, v162
    v_cvt_pk_bf16_f32 v163, v163, v163
    v_lshlrev_b32 v160, 16, v160
    v_lshlrev_b32 v161, 16, v161
    v_lshlrev_b32 v162, 16, v162
    v_lshlrev_b32 v163, 16, v163
    v_fma_f32 v160, v160, s75, v233
    v_fma_f32 v161, v161, s75, v233
    v_fma_f32 v162, v162, s75, v233
    v_fma_f32 v163, v163, s75, v233
    ds_write_b32 v156, v160 offset:0
    ds_write_b32 v156, v160 offset:1052
    ds_write_b32 v156, v160 offset:2168
    ds_write_b32 v156, v160 offset:3220
    ds_write_b32 v157, v161 offset:0
    ds_write_b32 v157, v161 offset:1052
    ds_write_b32 v157, v161 offset:2168
    ds_write_b32 v157, v161 offset:3220
    ds_write_b32 v158, v162 offset:0
    ds_write_b32 v158, v162 offset:1052
    ds_write_b32 v158, v162 offset:2168
    ds_write_b32 v158, v162 offset:3220
    ds_write_b32 v159, v163 offset:0
    ds_write_b32 v159, v163 offset:1052
    ds_write_b32 v159, v163 offset:2168
    ds_write_b32 v159, v163 offset:3220
L_nomlp:
    s_cmp_le_u32 s70, 0x423c0000
    s_cselect_b32 s71, 1, 0
    s_waitcnt vmcnt(0) lgkmcnt(0)
    s_barrier
    s_or_b32 s73, s65, s67
    s_cmp_eq_u32 s73, 0
    s_cbranch_scc1 L_nomask1
    v_mbcnt_lo_u32_b32 v12, -1, 0
    v_mbcnt_hi_u32_b32 v12, -1, v12
    v_bfe_u32 v11, v12, 2, 1
    v_and_b32 v11, s65, v11
    v_cmp_eq_u32 vcc, 1, v11
    v_mov_b32 v11, 0x0000ffff
    v_mov_b32 v13, 0xffff0000
    v_cndmask_b32 v11, v11, v13, vcc
    v_lshrrev_b32 v12, 5, v12
    v_cmp_eq_u32 vcc, 0, v12
    s_nop 1
    v_cndmask_b32 v13, 0, v11, vcc
    v_and_b32 v94, 0x3f803f80, v13
    v_mov_b32 v95, v94
    v_not_b32 v13, v13
    v_and_b32 v110, 0xc310c310, v13
    v_and_b32 v111, 0xbe8abe8a, v13
    v_cmp_eq_u32 vcc, s67, v12
    s_nop 1
    v_cndmask_b32 v13, 0, v11, vcc
    v_and_b32 v102, 0x3f803f80, v13
    v_mov_b32 v103, v102
    v_not_b32 v13, v13
    v_and_b32 v118, 0xc310c310, v13
    v_and_b32 v119, 0xbe8abe8a, v13
    s_nop 1
L_nomask1:
    s_cmp_eq_u32 s71, 0
    s_cbranch_scc1 L_slow_RA
    s_cmp_lg_u32 s59, 0
    s_cbranch_scc1 L_pr0
    s_setprio 2
L_pr0:
    s_cmp_lg_u32 s59, 1
    s_cbranch_scc1 L_pr1
    s_setprio 1
L_pr1:
    s_cmp_eq_u32 s69, 0
    s_cbranch_scc1 L_cx1_0
    s_add_u32 m0, s28, 0
    s_nop 0
    buffer_load_dwordx4 v187, s[8:11], 0 offen nt lds
L_cx1_0:
    v_and_b32 v202, 7, v192
    ds_read_b64_tr_b16 v[16:17], v104 offset:0
    s_cmp_eq_u32 s69, 0
    s_cbranch_scc1 L_cx1_1
    s_add_u32 m0, s28, 1024
    s_nop 0
    buffer_load_dwordx4 v188, s[8:11], 0 offen nt lds
L_cx1_1:
    ds_read_b64_tr_b16 v[18:19], v104 offset:2304
    ds_read_b64_tr_b16 v[40:41], v104 offset:192
    s_cmp_eq_u32 s69, 0
    s_cbranch_scc1 L_cx1_2
    s_add_u32 m0, s28, 2048
    s_nop 0
    buffer_load_dwordx4 v189, s[8:11], 0 offen nt lds
L_cx1_2:
    ds_read_b64_tr_b16 v[42:43], v104 offset:2496
    ds_read_b64_tr_b16 v[64:65], v104 offset:384
    s_cmp_lg_u32 s59, 0
    s_cbranch_scc1 L_cw1_0
    s_add_u32 m0, s30, 104448
    s_nop 0
    buffer_load_dwordx4 v194, s[16:19], s30 offen lds
L_cw1_0:
    ds_read_b64_tr_b16 v[66:67], v104 offset:2688
    ds_read_b128 v[232:235], v2 offset:24576
    v_sub_u32 v202, 7, v202
    v_lshl_add_u32 v202, v193, 2, v202
    v_and_b32 v203, 3, v202
    s_cmp_lg_u32 s59, 0
    s_cbranch_scc1 L_cw1_1
    s_add_u32 m0, s31, 104448
    s_nop 0
    buffer_load_dwordx4 v194, s[16:19], s31 offen lds
L_cw1_1:
    v_lshrrev_b32 v199, 1, v203
    v_mul_u32_u24 v203, 66, v203
    ds_read_b64_tr_b16 v[20:21], v104 offset:9216
    ds_read_b64_tr_b16 v[22:23], v104 offset:11520
    ds_read_b64_tr_b16 v[44:45], v104 offset:9408
    ds_read_b64_tr_b16 v[46:47], v104 offset:11712
    ds_read_b64_tr_b16 v[68:69], v104 offset:9600
    ds_read_b64_tr_b16 v[70:71], v104 offset:11904
    ds_read_b128 v[236:239], v3 offset:24576
    v_lshl_add_u32 v203, v199, 2, v203
    v_lshrrev_b32 v202, 2, v202
    v_add_u32 v203, v203, v202
    v_lshrrev_b32 v202, 3, v192
    s_mul_i32 s74, s59, 12288
    v_lshl_add_u32 v203, v202, 2, v203
    s_add_u32 s74, s74, 30720
    s_mul_i32 s75, s60, 3072
    s_mul_i32 s73, s60, 4192
    s_add_u32 s75, s75, s74
    v_mul_u32_u24 v202, 48, v192
    ds_read_b64_tr_b16 v[24:25], v104 offset:18432
    ds_read_b64_tr_b16 v[26:27], v104 offset:20736
    ds_read_b64_tr_b16 v[48:49], v104 offset:18624
    s_waitcnt lgkmcnt(10)
    v_mfma_f32_32x32x16_bf16 v[136:151], v[16:19], v[232:235], 0
    ds_read_b64_tr_b16 v[50:51], v104 offset:20928
    ds_read_b64_tr_b16 v[72:73], v104 offset:18816
    ds_read_b64_tr_b16 v[74:75], v104 offset:21120
    ds_read_b128 v[240:243], v2 offset:24640
    s_add_u32 s73, s73, 122880
    v_add_u32 v202, s75, v202
    v_mfma_f32_32x32x16_bf16 v[152:167], v[40:43], v[232:235], 0
    v_lshl_add_u32 v0, v203, 4, s73
    v_lshl_add_u32 v4, v193, 4, v202
    v_lshl_add_u32 v5, v193, 3, v202
    s_mul_i32 s78, s60, 768
    s_cmp_lg_u32 s59, 0
    s_cbranch_scc1 L_cw1_2
    s_add_u32 m0, s32, 104448
    s_nop 0
    buffer_load_dwordx4 v194, s[16:19], s32 offen lds
L_cw1_2:
    v_mfma_f32_32x32x16_bf16 v[168:183], v[232:235], v[64:67], 0
    s_add_u32 s78, s78, s74
    v_mul_u32_u24 v202, 48, v190
    v_mul_u32_u24 v203, 3072, v191
    v_add3_u32 v6, v202, v203, s78
    v_lshrrev_b32 v202, 2, v190
    ds_read_b64_tr_b16 v[28:29], v104 offset:27648
    s_waitcnt lgkmcnt(8)
    v_mfma_f32_32x32x16_bf16 v[136:151], v[20:23], v[236:239], v[136:151]
    ds_read_b64_tr_b16 v[30:31], v104 offset:29952
    ds_read_b64_tr_b16 v[52:53], v104 offset:27840
    ds_read_b64_tr_b16 v[54:55], v104 offset:30144
    ds_read_b64_tr_b16 v[76:77], v104 offset:28032
    ds_read_b64_tr_b16 v[78:79], v104 offset:30336
    ds_read_b128 v[244:247], v3 offset:24640
    v_mfma_f32_32x32x16_bf16 v[152:167], v[44:47], v[236:239], v[152:167]
    v_mad_u32_u24 v202, v191, 24, v202
    v_mul_u32_u24 v202, 192, v202
    v_and_b32 v203, 3, v190
    v_lshl_add_u32 v202, v203, 4, v202
    v_add_u32 v7, 104448, v202
    v_and_b32 v202, 7, v190
    v_mfma_f32_32x32x16_bf16 v[168:183], v[236:239], v[68:71], v[168:183]
    ds_read_b64_tr_b16 v[32:33], v104 offset:36864
    ds_read_b64_tr_b16 v[34:35], v104 offset:39168
    ds_read_b64_tr_b16 v[56:57], v104 offset:37056
    ds_read_b64_tr_b16 v[58:59], v104 offset:39360
    ds_read_b64_tr_b16 v[80:81], v104 offset:37248
    ds_read_b64_tr_b16 v[82:83], v104 offset:39552
    s_waitcnt lgkmcnt(13)
    v_mfma_f32_32x32x16_bf16 v[136:151], v[24:27], v[240:243], v[136:151]
    ds_read_b128 v[248:251], v2 offset:24704
    v_lshlrev_b32 v202, 2, v202
    s_cmp_lg_u32 s59, 0
    s_cbranch_scc1 L_cw1_3
    s_add_u32 m0, s33, 104448
    s_nop 0
    buffer_load_dwordx4 v194, s[16:19], s33 offen lds
L_cw1_3:
    v_mfma_f32_32x32x16_bf16 v[152:167], v[48:51], v[240:243], v[152:167]
    ds_read_b128 v[232:235], v2 offset:30720
    v_add_u32 v1, 139680, v202
    v_and_b32 v203, 7, v190
    v_lshrrev_b32 v202, 3, v190
    v_mul_u32_u24 v203, 192, v203
    v_mul_u32_u24 v202, 43008, v202
    v_mfma_f32_32x32x16_bf16 v[168:183], v[240:243], v[72:75], v[168:183]
    v_lshl_add_u32 v203, v191, 4, v203
    v_add_u32 v202, v202, v203
    ds_read_b64_tr_b16 v[36:37], v104 offset:46080
    ds_read_b64_tr_b16 v[38:39], v104 offset:48384
    ds_read_b64_tr_b16 v[60:61], v104 offset:46272
    ds_read_b64_tr_b16 v[62:63], v104 offset:48576
    s_waitcnt lgkmcnt(12)
    v_mfma_f32_32x32x16_bf16 v[136:151], v[28:31], v[244:247], v[136:151]
    ds_read_b64_tr_b16 v[84:85], v104 offset:46464
    ds_read_b64_tr_b16 v[86:87], v104 offset:48768
    ds_read_b128 v[252:255], v3 offset:24704
    ds_read_b128 v[236:239], v3 offset:30720
    v_bfe_u32 v203, v190, 2, 1
    v_mul_u32_u24 v203, 43008, v203
    v_mfma_f32_32x32x16_bf16 v[152:167], v[52:55], v[244:247], v[152:167]
    v_and_b32 v199, s65, v203
    v_sub_u32 v199, v202, v199
    v_add_u32 v8, s63, v199
    s_cmp_lg_u32 s59, 0
    s_cbranch_scc1 L_cw1_4
    s_add_u32 m0, s34, 104448
    s_nop 0
    buffer_load_dwordx4 v194, s[16:19], s34 offen lds
L_cw1_4:
    v_mfma_f32_32x32x16_bf16 v[168:183], v[244:247], v[76:79], v[168:183]
    ds_read_b128 v[240:243], v2 offset:30784
    v_and_b32 v199, s66, v203
    v_sub_u32 v199, v202, v199
    v_mov_b32 v202, s70
    v_mul_f32 v202, 0x3fb8aa3b, v202
    v_cmp_eq_u32 vcc, 0, v193
    s_nop 1
    v_cndmask_b32 v10, 1.0, v202, vcc
    s_waitcnt lgkmcnt(10)
    v_mfma_f32_32x32x16_bf16 v[136:151], v[32:35], v[248:251], v[136:151]
    ds_read_b128 v[244:247], v3 offset:30784
    v_add_u32 v9, s37, v199
    v_mov_b32 v13, s79
    v_mov_b32 v14, 1
    ds_write_b32 v13, v14 offset:32
    v_mov_b32 v120, 0x3f803f80
    v_mfma_f32_32x32x16_bf16 v[152:167], v[56:59], v[248:251], v[152:167]
    v_mov_b32 v121, 0x3f803f80
    v_mov_b32 v122, 0x3f803f80
    v_mov_b32 v123, 0x3f803f80
    v_mov_b32 v124, 0x3f803f80
    v_mov_b32 v125, 0x3f803f80
    v_mov_b32 v126, 0x3f803f80
    v_mfma_f32_32x32x16_bf16 v[168:183], v[248:251], v[80:83], v[168:183]
    ds_read_b128 v[248:251], v2 offset:30848
    v_mov_b32 v127, 0x3f803f80
    s_mov_b32 s76, 0x00ffffff
    s_mov_b32 s77, 0x00ffffff
    v_mov_b32 v128, 0x3f803f80
    v_mov_b32 v129, 0x3f803f80
    s_waitcnt lgkmcnt(12)
    v_mfma_f32_32x32x16_bf16 v[184:199], v[16:19], v[232:235], 0
    v_mov_b32 v130, 0x3f803f80
    v_mov_b32 v131, 0x3f803f80
    v_mov_b32 v132, 0x3f803f80
    v_mov_b32 v133, 0x3f803f80
    v_mov_b32 v134, 0x3f803f80
    v_mov_b32 v135, 0x3f803f80
    v_mfma_f32_32x32x16_bf16 v[200:215], v[40:43], v[232:235], 0
    s_mov_b32 s82, 0x3c2aaaab
    s_mov_b32 s83, 0x3727c5ac
    v_add_u32 v5, 32, v5
    s_mov_b32 s20, s56
    s_and_b32 s21, s57, 0xffff
    s_mov_b32 s22, 9633792
    s_waitcnt lgkmcnt(5)
    v_mfma_f32_32x32x16_bf16 v[136:151], v[36:39], v[252:255], v[136:151]
    s_mov_b32 s23, 0x00020000
    v_mfma_f32_32x32x16_bf16 v[152:167], v[60:63], v[252:255], v[152:167]
    s_nop 3
    v_fmaak_f32 v11, v136, v136, 0x2b0cbccc
    v_fmac_f32 v11, v137, v137
    v_fmac_f32 v11, v138, v138
    v_mfma_f32_32x32x16_bf16 v[168:183], v[252:255], v[84:87], v[168:183]
    ds_read_b128 v[252:255], v3 offset:30848
    v_fmac_f32 v11, v139, v139
    v_fmac_f32 v11, v140, v140
    s_nop 0
    v_fmaak_f32 v12, v152, v152, 0x2b0cbccc
    v_fmac_f32 v12, v153, v153
    v_fmac_f32 v12, v154, v154
    s_waitcnt lgkmcnt(5)
    v_mfma_f32_32x32x16_bf16 v[184:199], v[20:23], v[236:239], v[184:199]
    v_fmac_f32 v12, v155, v155
    v_fmac_f32 v12, v156, v156
    v_fmac_f32 v11, v141, v141
    v_fmac_f32 v12, v157, v157
    v_fmac_f32 v11, v142, v142
    v_fmac_f32 v12, v158, v158
    v_mfma_f32_32x32x16_bf16 v[200:215], v[44:47], v[236:239], v[200:215]
    v_fmac_f32 v11, v143, v143
    v_fmac_f32 v12, v159, v159
    v_fmac_f32 v11, v144, v144
    v_fmac_f32 v12, v160, v160
    v_fmac_f32 v11, v145, v145
    v_fmac_f32 v12, v161, v161
    s_waitcnt lgkmcnt(4)
    v_mfma_f32_32x32x16_bf16 v[184:199], v[24:27], v[240:243], v[184:199]
    v_fmac_f32 v11, v146, v146
    v_fmac_f32 v12, v162, v162
    v_fmac_f32 v11, v147, v147
    v_fmac_f32 v12, v163, v163
    ds_read_b128 v[148:151], v0 offset:256
    ds_read_b128 v[164:167], v0 offset:0
    v_mfma_f32_32x32x16_bf16 v[200:215], v[48:51], v[240:243], v[200:215]
    v_permlane32_swap_b32 v11, v12
    v_add_f32 v11, v11, v12
    v_rsq_f32 v11, v11
    s_mov_b64 exec, s[76:77]
    v_cvt_pk_bf16_f32 v120, v168, v169
    v_cvt_pk_bf16_f32 v121, v170, v171
    v_cvt_pk_bf16_f32 v122, v172, v173
    v_cvt_pk_bf16_f32 v123, v174, v175
    v_cvt_pk_bf16_f32 v124, v176, v177
    v_cvt_pk_bf16_f32 v125, v178, v179
    v_cvt_pk_bf16_f32 v126, v180, v181
    v_cvt_pk_bf16_f32 v127, v182, v183
    s_mov_b64 exec, -1
    s_waitcnt lgkmcnt(5)
    v_mfma_f32_32x32x16_bf16 v[184:199], v[28:31], v[244:247], v[184:199]
    v_mul_f32 v11, v11, v10
    v_mov_b32 v12, v11
    s_nop 1
    v_permlane32_swap_b32 v11, v12
    v_mfma_f32_32x32x16_bf16 v[200:215], v[52:55], v[244:247], v[200:215]
    v_mul_f32 v136, v136, v11
    v_mul_f32 v137, v137, v11
    v_mul_f32 v138, v138, v11
    v_mul_f32 v139, v139, v11
    v_mul_f32 v140, v140, v11
    v_mul_f32 v141, v141, v11
    s_waitcnt lgkmcnt(3)
    v_mfma_f32_32x32x16_bf16 v[184:199], v[32:35], v[248:251], v[184:199]
    v_mul_f32 v142, v142, v11
    v_mul_f32 v143, v143, v11
    v_mul_f32 v144, v144, v11
    v_mul_f32 v145, v145, v11
    v_mul_f32 v146, v146, v11
    v_mul_f32 v147, v147, v11
    v_mfma_f32_32x32x16_bf16 v[200:215], v[56:59], v[248:251], v[200:215]
    v_cvt_pk_bf16_f32 v88, v136, v137
    v_cvt_pk_bf16_f32 v89, v138, v139
    v_cvt_pk_bf16_f32 v90, v140, v141
    v_cvt_pk_bf16_f32 v91, v142, v143
    v_cvt_pk_bf16_f32 v92, v144, v145
    v_cvt_pk_bf16_f32 v93, v146, v147
    s_waitcnt lgkmcnt(2)
    v_mfma_f32_32x32x16_bf16 v[184:199], v[36:39], v[252:255], v[184:199]
    ds_read_b128 v[136:139], v0 offset:448
    ds_read_b128 v[140:143], v0 offset:384
    ds_read_b128 v[144:147], v0 offset:320
    v_mul_f32 v152, v152, v12
    v_mul_f32 v153, v153, v12
    v_mul_f32 v154, v154, v12
    v_mfma_f32_32x32x16_bf16 v[200:215], v[60:63], v[252:255], v[200:215]
    v_mul_f32 v155, v155, v12
    v_mul_f32 v156, v156, v12
    v_mul_f32 v157, v157, v12
    s_nop 0
    v_fmaak_f32 v13, v184, v184, 0x2b0cbccc
    v_fmac_f32 v13, v185, v185
    v_fmac_f32 v13, v186, v186
    v_mfma_f32_32x32x16_bf16 v[216:231], v[232:235], v[64:67], 0
    v_fmac_f32 v13, v187, v187
    v_fmac_f32 v13, v188, v188
    v_fmac_f32 v13, v189, v189
    s_nop 0
    v_fmaak_f32 v14, v200, v200, 0x2b0cbccc
    v_fmac_f32 v14, v201, v201
    v_fmac_f32 v14, v202, v202
    v_mfma_f32_32x32x16_bf16 v[216:231], v[236:239], v[68:71], v[216:231]
    v_fmac_f32 v14, v203, v203
    v_fmac_f32 v14, v204, v204
    v_fmac_f32 v14, v205, v205
    v_fmac_f32 v13, v190, v190
    v_fmac_f32 v14, v206, v206
    v_fmac_f32 v13, v191, v191
    v_mfma_f32_32x32x16_bf16 v[216:231], v[240:243], v[72:75], v[216:231]
    v_fmac_f32 v14, v207, v207
    v_fmac_f32 v13, v192, v192
    v_fmac_f32 v14, v208, v208
    v_fmac_f32 v13, v193, v193
    v_fmac_f32 v14, v209, v209
    v_fmac_f32 v13, v194, v194
    v_mfma_f32_32x32x16_bf16 v[216:231], v[244:247], v[76:79], v[216:231]
    v_fmac_f32 v14, v210, v210
    v_fmac_f32 v13, v195, v195
    v_fmac_f32 v14, v211, v211
    ds_read_b128 v[196:199], v0 offset:512
    v_mul_f32 v158, v158, v12
    v_permlane32_swap_b32 v13, v14
    v_mfma_f32_32x32x16_bf16 v[216:231], v[248:251], v[80:83], v[216:231]
    v_add_f32 v13, v13, v14
    v_rsq_f32 v13, v13
    v_mul_f32 v159, v159, v12
    v_mul_f32 v13, v13, v10
    v_mov_b32 v14, v13
    v_mfma_f32_32x32x16_bf16 v[216:231], v[252:255], v[84:87], v[216:231]
    s_nop 0
    v_permlane32_swap_b32 v13, v14
    v_mul_f32 v184, v184, v13
    v_mul_f32 v185, v185, v13
    v_mul_f32 v186, v186, v13
    v_mul_f32 v187, v187, v13
    v_mul_f32 v188, v188, v13
    v_mul_f32 v189, v189, v13
    v_mul_f32 v190, v190, v13
    v_mul_f32 v191, v191, v13
    v_mul_f32 v192, v192, v13
    v_mul_f32 v193, v193, v13
    v_mul_f32 v194, v194, v13
    v_mul_f32 v195, v195, v13
    v_cvt_pk_bf16_f32 v96, v184, v185
    v_cvt_pk_bf16_f32 v97, v186, v187
    v_cvt_pk_bf16_f32 v98, v188, v189
    v_cvt_pk_bf16_f32 v99, v190, v191
    v_cvt_pk_bf16_f32 v100, v192, v193
    v_cvt_pk_bf16_f32 v101, v194, v195
    ds_read_b128 v[184:187], v0 offset:704
    ds_read_b128 v[188:191], v0 offset:640
    ds_read_b128 v[192:195], v0 offset:576
    v_mul_f32 v160, v160, v12
    v_mul_f32 v161, v161, v12
    v_mul_f32 v162, v162, v12
    v_mul_f32 v163, v163, v12
    v_mul_f32 v200, v200, v14
    v_mul_f32 v201, v201, v14
    v_mul_f32 v202, v202, v14
    v_mul_f32 v203, v203, v14
    v_mul_f32 v204, v204, v14
    v_mul_f32 v205, v205, v14
    v_mul_f32 v206, v206, v14
    v_mul_f32 v207, v207, v14
    v_mul_f32 v208, v208, v14
    v_mul_f32 v209, v209, v14
    v_mul_f32 v210, v210, v14
    v_mul_f32 v211, v211, v14
    v_cvt_pk_bf16_f32 v104, v152, v153
    v_cvt_pk_bf16_f32 v105, v154, v155
    v_cvt_pk_bf16_f32 v106, v156, v157
    v_cvt_pk_bf16_f32 v107, v158, v159
    v_cvt_pk_bf16_f32 v108, v160, v161
    v_cvt_pk_bf16_f32 v109, v162, v163
    s_waitcnt lgkmcnt(4)
    v_mfma_f32_32x32x16_bf16 v[136:151], v[104:107], v[88:91], v[136:151]
    v_cvt_pk_bf16_f32 v112, v200, v201
    v_cvt_pk_bf16_f32 v113, v202, v203
    v_cvt_pk_bf16_f32 v114, v204, v205
    v_cvt_pk_bf16_f32 v115, v206, v207
    v_cvt_pk_bf16_f32 v116, v208, v209
    v_cvt_pk_bf16_f32 v117, v210, v211
    v_mfma_f32_32x32x16_bf16 v[136:151], v[108:111], v[92:95], v[136:151]
    ds_read_b128 v[152:155], v0 offset:192
    ds_read_b128 v[156:159], v0 offset:128
    ds_read_b128 v[160:163], v0 offset:64
    ds_read_b128 v[200:203], v0 offset:448
    ds_read_b128 v[204:207], v0 offset:384
    ds_read_b128 v[208:211], v0 offset:320
    s_waitcnt lgkmcnt(6)
    v_mfma_f32_32x32x16_bf16 v[184:199], v[104:107], v[96:99], v[184:199]
    ds_read_b128 v[212:215], v0 offset:256
    s_mov_b64 exec, s[76:77]
    v_cvt_pk_bf16_f32 v128, v216, v217
    v_cvt_pk_bf16_f32 v129, v218, v219
    v_cvt_pk_bf16_f32 v130, v220, v221
    v_cvt_pk_bf16_f32 v131, v222, v223
    v_cvt_pk_bf16_f32 v132, v224, v225
    v_cvt_pk_bf16_f32 v133, v226, v227
    v_cvt_pk_bf16_f32 v134, v228, v229
    v_cvt_pk_bf16_f32 v135, v230, v231
    s_mov_b64 exec, -1
    v_mfma_f32_32x32x16_bf16 v[184:199], v[108:111], v[100:103], v[184:199]
    v_exp_f32 v136, v136
    v_exp_f32 v137, v137
    v_exp_f32 v138, v138
    v_exp_f32 v139, v139
    v_exp_f32 v140, v140
    v_exp_f32 v141, v141
    s_nop 5
    v_exp_f32 v184, v184
    v_exp_f32 v185, v185
    s_waitcnt lgkmcnt(4)
    v_mfma_f32_32x32x16_bf16 v[152:167], v[112:115], v[88:91], v[152:167]
    v_exp_f32 v186, v186
    v_exp_f32 v187, v187
    v_exp_f32 v142, v142
    s_waitcnt lgkmcnt(0)
    v_mfma_f32_32x32x16_bf16 v[200:215], v[112:115], v[96:99], v[200:215]
    v_exp_f32 v143, v143
    v_exp_f32 v188, v188
    v_exp_f32 v189, v189
    v_mfma_f32_32x32x16_bf16 v[152:167], v[116:119], v[92:95], v[152:167]
    v_exp_f32 v190, v190
    v_exp_f32 v191, v191
    v_cvt_pk_bf16_f32 v136, v136, v137
    v_cvt_pk_bf16_f32 v184, v184, v185
    v_mfma_f32_32x32x16_bf16 v[200:215], v[116:119], v[100:103], v[200:215]
    v_cvt_pk_bf16_f32 v137, v138, v139
    v_cvt_pk_bf16_f32 v185, v186, v187
    v_cvt_pk_bf16_f32 v138, v140, v141
    v_cvt_pk_bf16_f32 v139, v142, v143
    v_cvt_pk_bf16_f32 v186, v188, v189
    v_cvt_pk_bf16_f32 v187, v190, v191
    v_mfma_f32_32x32x16_bf16 v[168:183], v[120:123], v[136:139], 0
    v_exp_f32 v144, v144
    v_exp_f32 v145, v145
    v_exp_f32 v146, v146
    v_mfma_f32_32x32x16_bf16 v[216:231], v[120:123], v[184:187], 0
    v_exp_f32 v147, v147
    v_exp_f32 v148, v148
    v_exp_f32 v149, v149
    v_exp_f32 v150, v150
    v_exp_f32 v151, v151
    v_exp_f32 v192, v192
    v_exp_f32 v193, v193
    v_exp_f32 v194, v194
    v_exp_f32 v195, v195
    v_exp_f32 v196, v196
    v_exp_f32 v197, v197
    v_exp_f32 v198, v198
    v_exp_f32 v199, v199
    v_cvt_pk_bf16_f32 v140, v144, v145
    v_cvt_pk_bf16_f32 v141, v146, v147
    v_cvt_pk_bf16_f32 v142, v148, v149
    v_cvt_pk_bf16_f32 v143, v150, v151
    v_cvt_pk_bf16_f32 v188, v192, v193
    v_cvt_pk_bf16_f32 v189, v194, v195
    v_mfma_f32_32x32x16_bf16 v[168:183], v[124:127], v[140:143], v[168:183]
    v_cvt_pk_bf16_f32 v190, v196, v197
    v_cvt_pk_bf16_f32 v191, v198, v199
    v_exp_f32 v152, v152
    v_exp_f32 v153, v153
    v_mfma_f32_32x32x16_bf16 v[216:231], v[124:127], v[188:191], v[216:231]
    v_exp_f32 v200, v200
    v_exp_f32 v201, v201
    v_exp_f32 v154, v154
    v_exp_f32 v155, v155
    v_exp_f32 v202, v202
    v_exp_f32 v203, v203
    v_exp_f32 v156, v156
    v_exp_f32 v157, v157
    v_exp_f32 v158, v158
    v_exp_f32 v159, v159
    v_exp_f32 v204, v204
    v_exp_f32 v205, v205
    v_exp_f32 v206, v206
    v_exp_f32 v207, v207
    v_cvt_pk_bf16_f32 v152, v152, v153
    v_cvt_pk_bf16_f32 v200, v200, v201
    v_cvt_pk_bf16_f32 v153, v154, v155
    v_cvt_pk_bf16_f32 v201, v202, v203
    v_cvt_pk_bf16_f32 v154, v156, v157
    v_cvt_pk_bf16_f32 v155, v158, v159
    v_cvt_pk_bf16_f32 v202, v204, v205
    v_cvt_pk_bf16_f32 v203, v206, v207
    v_mfma_f32_32x32x16_bf16 v[168:183], v[128:131], v[152:155], v[168:183]
    v_exp_f32 v160, v160
    v_exp_f32 v161, v161
    v_exp_f32 v162, v162
    v_mfma_f32_32x32x16_bf16 v[216:231], v[128:131], v[200:203], v[216:231]
    v_exp_f32 v163, v163
    v_exp_f32 v164, v164
    v_exp_f32 v165, v165
    v_exp_f32 v166, v166
    v_exp_f32 v167, v167
    v_exp_f32 v208, v208
    v_exp_f32 v209, v209
    v_exp_f32 v210, v210
    v_exp_f32 v211, v211
    v_exp_f32 v212, v212
    v_exp_f32 v213, v213
    v_exp_f32 v214, v214
    v_exp_f32 v215, v215
    v_cvt_pk_bf16_f32 v156, v160, v161
    v_cvt_pk_bf16_f32 v157, v162, v163
    v_cvt_pk_bf16_f32 v158, v164, v165
    v_cvt_pk_bf16_f32 v159, v166, v167
    v_cvt_pk_bf16_f32 v204, v208, v209
    v_cvt_pk_bf16_f32 v205, v210, v211
    v_mfma_f32_32x32x16_bf16 v[168:183], v[132:135], v[156:159], v[168:183]
    v_cvt_pk_bf16_f32 v206, v212, v213
    v_cvt_pk_bf16_f32 v207, v214, v215
    ds_read_b32 v13, v1
    s_nop 0
    v_mfma_f32_32x32x16_bf16 v[216:231], v[132:135], v[204:207], v[216:231]
    s_nop 3
    v_rcp_f32 v11, v180
    s_nop 0
    v_mul_f32 v168, v168, v11
    v_mul_f32 v169, v169, v11
    v_cvt_pk_bf16_f32 v168, v168, v169
    v_mul_f32 v170, v170, v11
    v_mul_f32 v171, v171, v11
    s_nop 0
    v_rcp_f32 v12, v228
    v_cvt_pk_bf16_f32 v169, v170, v171
    v_mul_f32 v216, v216, v12
    v_mul_f32 v217, v217, v12
    v_cvt_pk_bf16_f32 v216, v216, v217
    v_mul_f32 v218, v218, v12
    v_mul_f32 v219, v219, v12
    v_mul_f32 v172, v172, v11
    v_mul_f32 v173, v173, v11
    v_cvt_pk_bf16_f32 v217, v218, v219
    v_mul_f32 v220, v220, v12
    v_mul_f32 v221, v221, v12
    v_cvt_pk_bf16_f32 v170, v172, v173
    v_mul_f32 v174, v174, v11
    v_mul_f32 v175, v175, v11
    v_mul_f32 v176, v176, v11
    v_mul_f32 v177, v177, v11
    v_mul_f32 v178, v178, v11
    v_mul_f32 v179, v179, v11
    v_cvt_pk_bf16_f32 v218, v220, v221
    v_mul_f32 v222, v222, v12
    v_mul_f32 v223, v223, v12
    v_mul_f32 v224, v224, v12
    v_mul_f32 v225, v225, v12
    v_mul_f32 v226, v226, v12
    v_mul_f32 v227, v227, v12
    v_cvt_pk_bf16_f32 v171, v174, v175
    v_cvt_pk_bf16_f32 v172, v176, v177
    v_cvt_pk_bf16_f32 v173, v178, v179
    v_cvt_pk_bf16_f32 v219, v222, v223
    v_cvt_pk_bf16_f32 v220, v224, v225
    v_cvt_pk_bf16_f32 v221, v226, v227
L_slow_RA_ret:
    s_waitcnt lgkmcnt(0)
    v_cmp_gt_u32 vcc, 1, v13
    s_cbranch_vccz L_slow_RA_go
L_poll0:
    ds_read_b32 v13, v1
    s_waitcnt lgkmcnt(0)
    v_cmp_gt_u32 vcc, 1, v13
    s_cbranch_vccz L_poll0_ok
    s_sub_u32 s80, s80, 1
    s_cbranch_scc0 L_poll0
L_poll0_ok:
L_slow_RA_go:
    ds_write_b128 v4, v[168:171] offset:0
    ds_write_b64 v5, v[172:173] offset:0
    ds_write_b128 v4, v[216:219] offset:1536
    ds_write_b64 v5, v[220:221] offset:1536
    s_waitcnt vmcnt(0)
    v_mov_b32 v11, s79
    v_mov_b32 v12, 2
    ds_write_b32 v11, v12
    s_cmp_eq_u32 s59, 0
    s_cbranch_scc1 L_skipwo
    v_subrev_u32 v14, 16, v15
L_poll1:
    ds_read_b32 v13, v14
    s_waitcnt lgkmcnt(0)
    v_cmp_gt_u32 vcc, 2, v13
    s_cbranch_vccz L_poll1_ok
    s_sub_u32 s80, s80, 1
    s_cbranch_scc0 L_poll1
L_poll1_ok:
L_skipwo:
L_poll2:
    ds_read_b32 v13, v15
    s_waitcnt lgkmcnt(0)
    v_cmp_gt_u32 vcc, 2, v13
    s_cbranch_vccz L_poll2_ok
    s_sub_u32 s80, s80, 1
    s_cbranch_scc0 L_poll2
L_poll2_ok:
    s_cmp_eq_u32 s69, 0
    s_cbranch_scc1 L_last
    s_cmp_lg_u32 s59, 0
    s_cbranch_scc1 L_half
    s_or_b32 s73, s66, s68
    s_or_b32 s73, s73, s65
    s_or_b32 s73, s73, s67
    s_cmp_eq_u32 s73, 0
    s_cbranch_scc1 L_nomask2
    v_mbcnt_lo_u32_b32 v12, -1, 0
    v_mbcnt_hi_u32_b32 v12, -1, v12
    v_bfe_u32 v11, v12, 2, 1
    v_and_b32 v11, s66, v11
    v_cmp_eq_u32 vcc, 1, v11
    v_mov_b32 v11, 0x0000ffff
    v_mov_b32 v13, 0xffff0000
    v_cndmask_b32 v11, v11, v13, vcc
    v_lshrrev_b32 v12, 5, v12
    v_cmp_eq_u32 vcc, 0, v12
    s_nop 1
    v_cndmask_b32 v13, 0, v11, vcc
    v_and_b32 v94, 0x3f803f80, v13
    v_mov_b32 v95, v94
    v_not_b32 v13, v13
    v_and_b32 v110, 0xc310c310, v13
    v_and_b32 v111, 0xbe8abe8a, v13
    v_cmp_eq_u32 vcc, s68, v12
    s_nop 1
    v_cndmask_b32 v13, 0, v11, vcc
    v_and_b32 v102, 0x3f803f80, v13
    v_mov_b32 v103, v102
    v_not_b32 v13, v13
    v_and_b32 v118, 0xc310c310, v13
    v_and_b32 v119, 0xbe8abe8a, v13
    s_nop 1
L_nomask2:
    s_cmp_eq_u32 s71, 0
    s_cbranch_scc1 L_slow_RB
    ds_read_b128 v[168:171], v6 offset:0
    ds_read_b64_tr_b16 v[184:185], v7 offset:0
    ds_read_b64_tr_b16 v[186:187], v7 offset:1536
    ds_read_b64_tr_b16 v[188:189], v7 offset:8
    ds_read_b64_tr_b16 v[190:191], v7 offset:1544
    ds_read_b64_tr_b16 v[192:193], v7 offset:64
    ds_read_b64_tr_b16 v[194:195], v7 offset:1600
    ds_read_b64_tr_b16 v[196:197], v7 offset:72
    ds_read_b64_tr_b16 v[198:199], v7 offset:1608
    ds_read_b64_tr_b16 v[180:181], v7 offset:128
    ds_read_b64_tr_b16 v[182:183], v7 offset:1664
    ds_read_b128 v[172:175], v6 offset:16
    ds_read_b128 v[176:179], v6 offset:32
    ds_read_b128 v[232:235], v2 offset:0
    ds_read_b128 v[236:239], v3 offset:0
    s_waitcnt lgkmcnt(12)
    v_mfma_f32_16x16x32_bf16 v[216:219], v[184:187], v[168:171], 0
    ds_read_b64_tr_b16 v[184:185], v7 offset:136
    ds_read_b64_tr_b16 v[186:187], v7 offset:1672
    s_waitcnt lgkmcnt(12)
    v_mfma_f32_16x16x32_bf16 v[220:223], v[188:191], v[168:171], 0
    ds_read_b64_tr_b16 v[188:189], v7 offset:768
    ds_read_b64_tr_b16 v[190:191], v7 offset:2304
    s_waitcnt lgkmcnt(12)
    v_mfma_f32_16x16x32_bf16 v[224:227], v[192:195], v[168:171], 0
    ds_read_b64_tr_b16 v[192:193], v7 offset:776
    ds_read_b64_tr_b16 v[194:195], v7 offset:2312
    s_waitcnt lgkmcnt(12)
    v_mfma_f32_16x16x32_bf16 v[228:231], v[196:199], v[168:171], 0
    ds_read_b64_tr_b16 v[196:197], v7 offset:832
    ds_read_b64_tr_b16 v[198:199], v7 offset:2368
    s_waitcnt lgkmcnt(12)
    v_mfma_f32_16x16x32_bf16 v[200:203], v[180:183], v[168:171], 0
    ds_read_b64_tr_b16 v[180:181], v7 offset:840
    ds_read_b64_tr_b16 v[182:183], v7 offset:2376
    s_waitcnt lgkmcnt(11)
    v_mfma_f32_32x32x16_bf16 v[136:151], v[16:19], v[232:235], 0
    ds_read_b128 v[240:243], v2 offset:64
    ds_read_b128 v[244:247], v3 offset:64
    ds_read_b128 v[248:251], v2 offset:128
    v_mfma_f32_32x32x16_bf16 v[152:167], v[40:43], v[232:235], 0
    ds_read_b128 v[252:255], v3 offset:128
    s_waitcnt lgkmcnt(14)
    v_mfma_f32_32x32x16_bf16 v[136:151], v[20:23], v[236:239], v[136:151]
    s_waitcnt lgkmcnt(12)
    v_mfma_f32_16x16x32_bf16 v[204:207], v[184:187], v[168:171], 0
    ds_read_b64_tr_b16 v[184:185], v7 offset:896
    ds_read_b64_tr_b16 v[186:187], v7 offset:2432
    s_waitcnt lgkmcnt(12)
    v_mfma_f32_16x16x32_bf16 v[216:219], v[188:191], v[172:175], v[216:219]
    ds_read_b64_tr_b16 v[188:189], v7 offset:904
    ds_read_b64_tr_b16 v[190:191], v7 offset:2440
    s_waitcnt lgkmcnt(12)
    v_mfma_f32_16x16x32_bf16 v[220:223], v[192:195], v[172:175], v[220:223]
    ds_read_b64_tr_b16 v[192:193], v7 offset:3072
    ds_read_b64_tr_b16 v[194:195], v7 offset:3840
    s_waitcnt lgkmcnt(12)
    v_mfma_f32_16x16x32_bf16 v[224:227], v[196:199], v[172:175], v[224:227]
    ds_read_b64_tr_b16 v[196:197], v7 offset:3080
    ds_read_b64_tr_b16 v[198:199], v7 offset:3848
    s_waitcnt lgkmcnt(12)
    v_mfma_f32_16x16x32_bf16 v[228:231], v[180:183], v[172:175], v[228:231]
    ds_read_b64_tr_b16 v[180:181], v7 offset:3136
    ds_read_b64_tr_b16 v[182:183], v7 offset:3904
    v_mfma_f32_32x32x16_bf16 v[152:167], v[44:47], v[236:239], v[152:167]
    s_waitcnt lgkmcnt(13)
    v_mfma_f32_32x32x16_bf16 v[136:151], v[24:27], v[240:243], v[136:151]
    v_mfma_f32_32x32x16_bf16 v[152:167], v[48:51], v[240:243], v[152:167]
    s_waitcnt lgkmcnt(8)
    v_mfma_f32_16x16x32_bf16 v[200:203], v[184:187], v[172:175], v[200:203]
    ds_read_b64_tr_b16 v[184:185], v7 offset:3144
    ds_read_b64_tr_b16 v[186:187], v7 offset:3912
    s_waitcnt lgkmcnt(8)
    v_mfma_f32_16x16x32_bf16 v[204:207], v[188:191], v[172:175], v[204:207]
    ds_read_b64_tr_b16 v[188:189], v7 offset:3200
    ds_read_b64_tr_b16 v[190:191], v7 offset:3968
    s_waitcnt lgkmcnt(8)
    v_mfma_f32_16x16x32_bf16 v[216:219], v[192:195], v[176:179], v[216:219]
    ds_read_b64_tr_b16 v[192:193], v7 offset:3208
    ds_read_b64_tr_b16 v[194:195], v7 offset:3976
    s_waitcnt lgkmcnt(8)
    v_mfma_f32_16x16x32_bf16 v[220:223], v[196:199], v[176:179], v[220:223]
    s_waitcnt lgkmcnt(6)
    v_mfma_f32_16x16x32_bf16 v[224:227], v[180:183], v[176:179], v[224:227]
    v_mul_f32 v14, v216, v216
    v_add_f32 v13, v216, v217
    v_mfma_f32_32x32x16_bf16 v[136:151], v[28:31], v[244:247], v[136:151]
    v_fmac_f32 v14, v217, v217
    v_add_f32 v13, v13, v218
    v_fmac_f32 v14, v218, v218
    v_add_f32 v13, v13, v219
    v_fmac_f32 v14, v219, v219
    v_add_f32 v13, v13, v220
    v_mfma_f32_32x32x16_bf16 v[152:167], v[52:55], v[244:247], v[152:167]
    v_fmac_f32 v14, v220, v220
    v_add_f32 v13, v13, v221
    v_fmac_f32 v14, v221, v221
    v_add_f32 v13, v13, v222
    v_fmac_f32 v14, v222, v222
    v_add_f32 v13, v13, v223
    v_mfma_f32_32x32x16_bf16 v[136:151], v[32:35], v[248:251], v[136:151]
    v_fmac_f32 v14, v223, v223
    v_add_f32 v13, v13, v224
    v_fmac_f32 v14, v224, v224
    v_add_f32 v13, v13, v225
    v_fmac_f32 v14, v225, v225
    v_add_f32 v13, v13, v226
    s_waitcnt lgkmcnt(4)
    v_mfma_f32_16x16x32_bf16 v[228:231], v[184:187], v[176:179], v[228:231]
    v_fmac_f32 v14, v226, v226
    v_add_f32 v13, v13, v227
    s_waitcnt lgkmcnt(2)
    v_mfma_f32_16x16x32_bf16 v[200:203], v[188:191], v[176:179], v[200:203]
    v_fmac_f32 v14, v227, v227
    s_waitcnt lgkmcnt(0)
    v_mfma_f32_16x16x32_bf16 v[204:207], v[192:195], v[176:179], v[204:207]
    v_add_f32 v13, v13, v228
    v_fmac_f32 v14, v228, v228
    v_mfma_f32_32x32x16_bf16 v[168:183], v[232:235], v[64:67], 0
    v_add_f32 v13, v13, v229
    v_fmac_f32 v14, v229, v229
    v_add_f32 v13, v13, v230
    v_fmac_f32 v14, v230, v230
    v_add_f32 v13, v13, v231
    v_fmac_f32 v14, v231, v231
    v_mfma_f32_32x32x16_bf16 v[168:183], v[236:239], v[68:71], v[168:183]
    v_add_f32 v13, v13, v200
    v_fmac_f32 v14, v200, v200
    v_add_f32 v13, v13, v201
    v_fmac_f32 v14, v201, v201
    v_add_f32 v13, v13, v202
    v_fmac_f32 v14, v202, v202
    v_mfma_f32_32x32x16_bf16 v[168:183], v[240:243], v[72:75], v[168:183]
    v_add_f32 v13, v13, v203
    v_fmac_f32 v14, v203, v203
    v_add_f32 v13, v13, v204
    v_fmac_f32 v14, v204, v204
    v_add_f32 v13, v13, v205
    v_fmac_f32 v14, v205, v205
    v_mfma_f32_32x32x16_bf16 v[168:183], v[244:247], v[76:79], v[168:183]
    v_add_f32 v13, v13, v206
    v_fmac_f32 v14, v206, v206
    v_add_f32 v13, v13, v207
    v_fmac_f32 v14, v207, v207
    ds_read_b128 v[232:235], v2 offset:6144
    ds_read_b128 v[236:239], v3 offset:6144
    v_mfma_f32_32x32x16_bf16 v[152:167], v[56:59], v[248:251], v[152:167]
    v_permlane32_swap_b32 v13, v14
    v_add_f32 v13, v13, v14
    v_mov_b32 v14, v13
    ds_read_b128 v[240:243], v2 offset:6208
    ds_read_b128 v[244:247], v3 offset:6208
    v_mfma_f32_32x32x16_bf16 v[168:183], v[248:251], v[80:83], v[168:183]
    v_permlane16_swap_b32 v13, v14
    v_add_f32 v13, v13, v14
    v_mov_b32 v14, v13
    ds_read_b128 v[248:251], v2 offset:6272
    v_mfma_f32_32x32x16_bf16 v[136:151], v[36:39], v[252:255], v[136:151]
    v_permlane32_swap_b32 v13, v14
    v_mul_f32 v13, s82, v13
    v_fma_f32 v1, -v13, v13, s83
    v_fma_f32 v14, v14, s82, v1
    v_rsq_f32 v14, v14
    v_mfma_f32_32x32x16_bf16 v[152:167], v[60:63], v[252:255], v[152:167]
    v_mul_f32 v13, -v13, v14
    v_fma_f32 v200, v200, v14, v13
    v_fma_f32 v201, v201, v14, v13
    v_fma_f32 v202, v202, v14, v13
    v_fma_f32 v203, v203, v14, v13
    v_cvt_pk_bf16_f32 v200, v200, v201
    s_waitcnt lgkmcnt(4)
    v_mfma_f32_32x32x16_bf16 v[184:199], v[16:19], v[232:235], 0
    v_fma_f32 v204, v204, v14, v13
    v_fma_f32 v205, v205, v14, v13
    v_fma_f32 v206, v206, v14, v13
    v_fma_f32 v207, v207, v14, v13
    v_cvt_pk_bf16_f32 v201, v202, v203
    v_cvt_pk_bf16_f32 v202, v204, v205
    v_mfma_f32_32x32x16_bf16 v[168:183], v[252:255], v[84:87], v[168:183]
    v_cvt_pk_bf16_f32 v203, v206, v207
    buffer_store_dwordx4 v[200:203], v8, s[20:23], 0 offen offset:128 sc1 nt
    ds_read_b128 v[252:255], v3 offset:6272
    v_fma_f32 v216, v216, v14, v13
    v_fma_f32 v217, v217, v14, v13
    v_fma_f32 v218, v218, v14, v13
    v_mfma_f32_32x32x16_bf16 v[200:215], v[40:43], v[232:235], 0
    v_fma_f32 v219, v219, v14, v13
    v_fma_f32 v220, v220, v14, v13
    v_fma_f32 v221, v221, v14, v13
    v_fma_f32 v222, v222, v14, v13
    v_fma_f32 v223, v223, v14, v13
    v_fma_f32 v224, v224, v14, v13
    s_waitcnt lgkmcnt(4)
    v_mfma_f32_32x32x16_bf16 v[184:199], v[20:23], v[236:239], v[184:199]
    v_fma_f32 v225, v225, v14, v13
    v_fma_f32 v226, v226, v14, v13
    v_fma_f32 v227, v227, v14, v13
    v_fma_f32 v228, v228, v14, v13
    v_fma_f32 v229, v229, v14, v13
    v_fma_f32 v230, v230, v14, v13
    v_mfma_f32_32x32x16_bf16 v[200:215], v[44:47], v[236:239], v[200:215]
    v_fma_f32 v231, v231, v14, v13
    v_fmaak_f32 v11, v136, v136, 0x2b0cbccc
    v_fmaak_f32 v12, v152, v152, 0x2b0cbccc
    v_fmac_f32 v11, v137, v137
    v_fmac_f32 v12, v153, v153
    v_fmac_f32 v11, v138, v138
    s_waitcnt lgkmcnt(3)
    v_mfma_f32_32x32x16_bf16 v[184:199], v[24:27], v[240:243], v[184:199]
    v_fmac_f32 v12, v154, v154
    v_fmac_f32 v11, v139, v139
    v_fmac_f32 v12, v155, v155
    v_fmac_f32 v11, v140, v140
    v_fmac_f32 v12, v156, v156
    v_fmac_f32 v11, v141, v141
    v_mfma_f32_32x32x16_bf16 v[200:215], v[48:51], v[240:243], v[200:215]
    v_fmac_f32 v12, v157, v157
    v_fmac_f32 v11, v142, v142
    v_fmac_f32 v12, v158, v158
    v_fmac_f32 v11, v143, v143
    v_fmac_f32 v12, v159, v159
    v_fmac_f32 v11, v144, v144
    s_waitcnt lgkmcnt(2)
    v_mfma_f32_32x32x16_bf16 v[184:199], v[28:31], v[244:247], v[184:199]
    v_fmac_f32 v12, v160, v160
    v_fmac_f32 v11, v145, v145
    v_fmac_f32 v12, v161, v161
    v_fmac_f32 v11, v146, v146
    v_fmac_f32 v12, v162, v162
    v_fmac_f32 v11, v147, v147
    v_mfma_f32_32x32x16_bf16 v[200:215], v[52:55], v[244:247], v[200:215]
    v_fmac_f32 v12, v163, v163
    v_cvt_pk_bf16_f32 v216, v216, v217
    v_cvt_pk_bf16_f32 v224, v224, v225
    v_permlane32_swap_b32 v11, v12
    v_add_f32 v11, v11, v12
    s_waitcnt lgkmcnt(1)
    v_mfma_f32_32x32x16_bf16 v[184:199], v[32:35], v[248:251], v[184:199]
    v_rsq_f32 v11, v11
    v_cvt_pk_bf16_f32 v217, v218, v219
    v_cvt_pk_bf16_f32 v225, v226, v227
    v_cvt_pk_bf16_f32 v218, v220, v221
    v_cvt_pk_bf16_f32 v219, v222, v223
    v_mfma_f32_32x32x16_bf16 v[200:215], v[56:59], v[248:251], v[200:215]
    v_cvt_pk_bf16_f32 v226, v228, v229
    v_cvt_pk_bf16_f32 v227, v230, v231
    v_mul_f32 v11, v11, v10
    buffer_store_dwordx4 v[216:219], v8, s[20:23], 0 offen offset:0 sc1 nt
    buffer_store_dwordx4 v[224:227], v8, s[20:23], 0 offen offset:64 sc1 nt
    v_mov_b32 v12, v11
    s_waitcnt lgkmcnt(0)
    v_mfma_f32_32x32x16_bf16 v[184:199], v[36:39], v[252:255], v[184:199]
    v_permlane32_swap_b32 v11, v12
    v_mul_f32 v136, v136, v11
    v_mul_f32 v137, v137, v11
    v_mul_f32 v138, v138, v11
    v_mul_f32 v139, v139, v11
    v_mfma_f32_32x32x16_bf16 v[200:215], v[60:63], v[252:255], v[200:215]
    v_mul_f32 v140, v140, v11
    v_mul_f32 v141, v141, v11
    v_mul_f32 v142, v142, v11
    s_nop 0
    v_fmaak_f32 v13, v184, v184, 0x2b0cbccc
    v_fmac_f32 v13, v185, v185
    v_fmac_f32 v13, v186, v186
    v_mfma_f32_32x32x16_bf16 v[216:231], v[232:235], v[64:67], 0
    v_fmac_f32 v13, v187, v187
    v_fmac_f32 v13, v188, v188
    v_fmac_f32 v13, v189, v189
    s_nop 0
    v_fmaak_f32 v14, v200, v200, 0x2b0cbccc
    v_fmac_f32 v14, v201, v201
    v_fmac_f32 v14, v202, v202
    v_mfma_f32_32x32x16_bf16 v[216:231], v[236:239], v[68:71], v[216:231]
    v_fmac_f32 v14, v203, v203
    v_fmac_f32 v14, v204, v204
    v_fmac_f32 v14, v205, v205
    v_fmac_f32 v13, v190, v190
    v_fmac_f32 v14, v206, v206
    v_fmac_f32 v13, v191, v191
    v_mfma_f32_32x32x16_bf16 v[216:231], v[240:243], v[72:75], v[216:231]
    v_fmac_f32 v14, v207, v207
    v_fmac_f32 v13, v192, v192
    v_fmac_f32 v14, v208, v208
    v_fmac_f32 v13, v193, v193
    v_fmac_f32 v14, v209, v209
    v_fmac_f32 v13, v194, v194
    v_mfma_f32_32x32x16_bf16 v[216:231], v[244:247], v[76:79], v[216:231]
    v_fmac_f32 v14, v210, v210
    v_fmac_f32 v13, v195, v195
    v_fmac_f32 v14, v211, v211
    v_mul_f32 v143, v143, v11
    v_mul_f32 v144, v144, v11
    v_permlane32_swap_b32 v13, v14
    v_mfma_f32_32x32x16_bf16 v[216:231], v[248:251], v[80:83], v[216:231]
    v_add_f32 v13, v13, v14
    v_rsq_f32 v13, v13
    v_mul_f32 v145, v145, v11
    v_mul_f32 v13, v13, v10
    v_mov_b32 v14, v13
    v_mfma_f32_32x32x16_bf16 v[216:231], v[252:255], v[84:87], v[216:231]
    s_nop 0
    v_permlane32_swap_b32 v13, v14
    v_mul_f32 v146, v146, v11
    v_mul_f32 v147, v147, v11
    v_mul_f32 v184, v184, v13
    v_mul_f32 v185, v185, v13
    v_mul_f32 v186, v186, v13
    v_mul_f32 v187, v187, v13
    v_mul_f32 v188, v188, v13
    v_mul_f32 v189, v189, v13
    v_mul_f32 v190, v190, v13
    v_mul_f32 v191, v191, v13
    v_mul_f32 v192, v192, v13
    v_mul_f32 v193, v193, v13
    v_mul_f32 v194, v194, v13
    v_mul_f32 v195, v195, v13
    v_cvt_pk_bf16_f32 v88, v136, v137
    v_cvt_pk_bf16_f32 v89, v138, v139
    v_cvt_pk_bf16_f32 v90, v140, v141
    v_cvt_pk_bf16_f32 v91, v142, v143
    v_cvt_pk_bf16_f32 v92, v144, v145
    v_cvt_pk_bf16_f32 v93, v146, v147
    v_cvt_pk_bf16_f32 v96, v184, v185
    v_cvt_pk_bf16_f32 v97, v186, v187
    v_cvt_pk_bf16_f32 v98, v188, v189
    v_cvt_pk_bf16_f32 v99, v190, v191
    v_cvt_pk_bf16_f32 v100, v192, v193
    v_cvt_pk_bf16_f32 v101, v194, v195
    ds_read_b128 v[136:139], v0 offset:448
    ds_read_b128 v[140:143], v0 offset:384
    ds_read_b128 v[144:147], v0 offset:320
    ds_read_b128 v[148:151], v0 offset:256
    ds_read_b128 v[184:187], v0 offset:704
    ds_read_b128 v[188:191], v0 offset:640
    ds_read_b128 v[192:195], v0 offset:576
    ds_read_b128 v[196:199], v0 offset:512
    v_mul_f32 v152, v152, v12
    v_mul_f32 v153, v153, v12
    v_mul_f32 v154, v154, v12
    v_mul_f32 v155, v155, v12
    v_mul_f32 v156, v156, v12
    v_mul_f32 v157, v157, v12
    v_mul_f32 v158, v158, v12
    v_mul_f32 v159, v159, v12
    v_mul_f32 v160, v160, v12
    v_mul_f32 v161, v161, v12
    v_mul_f32 v162, v162, v12
    v_mul_f32 v163, v163, v12
    v_mul_f32 v200, v200, v14
    v_mul_f32 v201, v201, v14
    v_mul_f32 v202, v202, v14
    v_mul_f32 v203, v203, v14
    v_mul_f32 v204, v204, v14
    v_mul_f32 v205, v205, v14
    v_mul_f32 v206, v206, v14
    v_mul_f32 v207, v207, v14
    v_mul_f32 v208, v208, v14
    v_mul_f32 v209, v209, v14
    v_mul_f32 v210, v210, v14
    v_mul_f32 v211, v211, v14
    v_cvt_pk_bf16_f32 v104, v152, v153
    v_cvt_pk_bf16_f32 v105, v154, v155
    v_cvt_pk_bf16_f32 v106, v156, v157
    v_cvt_pk_bf16_f32 v107, v158, v159
    v_cvt_pk_bf16_f32 v108, v160, v161
    v_cvt_pk_bf16_f32 v109, v162, v163
    s_waitcnt lgkmcnt(4)
    v_mfma_f32_32x32x16_bf16 v[136:151], v[104:107], v[88:91], v[136:151]
    v_cvt_pk_bf16_f32 v112, v200, v201
    v_cvt_pk_bf16_f32 v113, v202, v203
    v_cvt_pk_bf16_f32 v114, v204, v205
    v_cvt_pk_bf16_f32 v115, v206, v207
    v_cvt_pk_bf16_f32 v116, v208, v209
    v_cvt_pk_bf16_f32 v117, v210, v211
    s_waitcnt lgkmcnt(0)
    v_mfma_f32_32x32x16_bf16 v[184:199], v[104:107], v[96:99], v[184:199]
    ds_read_b128 v[152:155], v0 offset:192
    ds_read_b128 v[156:159], v0 offset:128
    ds_read_b128 v[160:163], v0 offset:64
    ds_read_b128 v[164:167], v0 offset:0
    ds_read_b128 v[200:203], v0 offset:448
    ds_read_b128 v[204:207], v0 offset:384
    v_mfma_f32_32x32x16_bf16 v[136:151], v[108:111], v[92:95], v[136:151]
    ds_read_b128 v[208:211], v0 offset:320
    ds_read_b128 v[212:215], v0 offset:256
    s_cmp_lg_u32 s59, 0
    s_cbranch_scc1 L_pr2
    s_setprio 0
L_pr2:
    s_mov_b64 exec, s[76:77]
    v_cvt_pk_bf16_f32 v120, v168, v169
    v_cvt_pk_bf16_f32 v121, v170, v171
    v_cvt_pk_bf16_f32 v122, v172, v173
    v_cvt_pk_bf16_f32 v123, v174, v175
    v_cvt_pk_bf16_f32 v124, v176, v177
    v_cvt_pk_bf16_f32 v125, v178, v179
    v_cvt_pk_bf16_f32 v126, v180, v181
    v_cvt_pk_bf16_f32 v127, v182, v183
    s_mov_b64 exec, -1
    v_mfma_f32_32x32x16_bf16 v[184:199], v[108:111], v[100:103], v[184:199]
    s_mov_b64 exec, s[76:77]
    v_cvt_pk_bf16_f32 v128, v216, v217
    v_cvt_pk_bf16_f32 v129, v218, v219
    v_cvt_pk_bf16_f32 v130, v220, v221
    v_cvt_pk_bf16_f32 v131, v222, v223
    v_cvt_pk_bf16_f32 v132, v224, v225
    v_cvt_pk_bf16_f32 v133, v226, v227
    v_cvt_pk_bf16_f32 v134, v228, v229
    v_cvt_pk_bf16_f32 v135, v230, v231
    s_mov_b64 exec, -1
    v_exp_f32 v136, v136
    v_exp_f32 v137, v137
    v_exp_f32 v184, v184
    s_waitcnt lgkmcnt(4)
    v_mfma_f32_32x32x16_bf16 v[152:167], v[112:115], v[88:91], v[152:167]
    v_exp_f32 v185, v185
    v_exp_f32 v138, v138
    v_exp_f32 v139, v139
    s_waitcnt lgkmcnt(0)
    v_mfma_f32_32x32x16_bf16 v[200:215], v[112:115], v[96:99], v[200:215]
    v_exp_f32 v186, v186
    v_exp_f32 v187, v187
    v_exp_f32 v140, v140
    v_mfma_f32_32x32x16_bf16 v[152:167], v[116:119], v[92:95], v[152:167]
    v_exp_f32 v141, v141
    v_exp_f32 v142, v142
    v_exp_f32 v143, v143
    v_mfma_f32_32x32x16_bf16 v[200:215], v[116:119], v[100:103], v[200:215]
    v_exp_f32 v188, v188
    v_exp_f32 v189, v189
    v_exp_f32 v190, v190
    v_exp_f32 v191, v191
    v_cvt_pk_bf16_f32 v136, v136, v137
    v_cvt_pk_bf16_f32 v184, v184, v185
    v_cvt_pk_bf16_f32 v137, v138, v139
    v_cvt_pk_bf16_f32 v185, v186, v187
    v_cvt_pk_bf16_f32 v138, v140, v141
    v_cvt_pk_bf16_f32 v139, v142, v143
    v_cvt_pk_bf16_f32 v186, v188, v189
    v_cvt_pk_bf16_f32 v187, v190, v191
    v_mfma_f32_32x32x16_bf16 v[168:183], v[120:123], v[136:139], 0
    v_exp_f32 v144, v144
    v_exp_f32 v145, v145
    v_exp_f32 v146, v146
    v_mfma_f32_32x32x16_bf16 v[216:231], v[120:123], v[184:187], 0
    v_exp_f32 v147, v147
    v_exp_f32 v148, v148
    v_exp_f32 v149, v149
    v_exp_f32 v150, v150
    v_exp_f32 v151, v151
    v_exp_f32 v192, v192
    v_exp_f32 v193, v193
    v_exp_f32 v194, v194
    v_exp_f32 v195, v195
    v_exp_f32 v196, v196
    v_exp_f32 v197, v197
    v_exp_f32 v198, v198
    v_exp_f32 v199, v199
    v_cvt_pk_bf16_f32 v140, v144, v145
    v_cvt_pk_bf16_f32 v141, v146, v147
    v_cvt_pk_bf16_f32 v142, v148, v149
    v_cvt_pk_bf16_f32 v143, v150, v151
    v_cvt_pk_bf16_f32 v188, v192, v193
    v_cvt_pk_bf16_f32 v189, v194, v195
    v_mfma_f32_32x32x16_bf16 v[168:183], v[124:127], v[140:143], v[168:183]
    v_cvt_pk_bf16_f32 v190, v196, v197
    v_cvt_pk_bf16_f32 v191, v198, v199
    v_exp_f32 v152, v152
    v_exp_f32 v153, v153
    v_mfma_f32_32x32x16_bf16 v[216:231], v[124:127], v[188:191], v[216:231]
    v_exp_f32 v200, v200
    v_exp_f32 v201, v201
    v_exp_f32 v154, v154
    v_exp_f32 v155, v155
    v_exp_f32 v202, v202
    v_exp_f32 v203, v203
    v_exp_f32 v156, v156
    v_exp_f32 v157, v157
    v_exp_f32 v158, v158
    v_exp_f32 v159, v159
    v_exp_f32 v204, v204
    v_exp_f32 v205, v205
    v_exp_f32 v206, v206
    v_exp_f32 v207, v207
    v_cvt_pk_bf16_f32 v152, v152, v153
    v_cvt_pk_bf16_f32 v200, v200, v201
    v_cvt_pk_bf16_f32 v153, v154, v155
    v_cvt_pk_bf16_f32 v201, v202, v203
    v_cvt_pk_bf16_f32 v154, v156, v157
    v_cvt_pk_bf16_f32 v155, v158, v159
    v_cvt_pk_bf16_f32 v202, v204, v205
    v_cvt_pk_bf16_f32 v203, v206, v207
    v_mfma_f32_32x32x16_bf16 v[168:183], v[128:131], v[152:155], v[168:183]
    v_exp_f32 v160, v160
    v_exp_f32 v161, v161
    v_exp_f32 v162, v162
    v_mfma_f32_32x32x16_bf16 v[216:231], v[128:131], v[200:203], v[216:231]
    v_exp_f32 v163, v163
    v_exp_f32 v164, v164
    v_exp_f32 v165, v165
    v_exp_f32 v166, v166
    v_exp_f32 v167, v167
    v_exp_f32 v208, v208
    v_exp_f32 v209, v209
    v_exp_f32 v210, v210
    v_exp_f32 v211, v211
    v_exp_f32 v212, v212
    v_exp_f32 v213, v213
    v_exp_f32 v214, v214
    v_exp_f32 v215, v215
    v_cvt_pk_bf16_f32 v156, v160, v161
    v_cvt_pk_bf16_f32 v157, v162, v163
    v_cvt_pk_bf16_f32 v158, v164, v165
    v_cvt_pk_bf16_f32 v159, v166, v167
    v_cvt_pk_bf16_f32 v204, v208, v209
    v_cvt_pk_bf16_f32 v205, v210, v211
    v_mfma_f32_32x32x16_bf16 v[168:183], v[132:135], v[156:159], v[168:183]
    v_cvt_pk_bf16_f32 v206, v212, v213
    v_cvt_pk_bf16_f32 v207, v214, v215
    s_nop 1
    v_mfma_f32_32x32x16_bf16 v[216:231], v[132:135], v[204:207], v[216:231]
    s_nop 3
    v_rcp_f32 v11, v180
    s_nop 0
    v_mul_f32 v168, v168, v11
    v_mul_f32 v169, v169, v11
    v_cvt_pk_bf16_f32 v168, v168, v169
    v_mul_f32 v170, v170, v11
    v_mul_f32 v171, v171, v11
    s_nop 0
    v_rcp_f32 v12, v228
    v_cvt_pk_bf16_f32 v169, v170, v171
    v_mul_f32 v216, v216, v12
    v_mul_f32 v217, v217, v12
    v_cvt_pk_bf16_f32 v216, v216, v217
    v_mul_f32 v218, v218, v12
    v_mul_f32 v219, v219, v12
    v_mul_f32 v172, v172, v11
    v_mul_f32 v173, v173, v11
    v_cvt_pk_bf16_f32 v217, v218, v219
    v_mul_f32 v220, v220, v12
    v_mul_f32 v221, v221, v12
    v_cvt_pk_bf16_f32 v170, v172, v173
    v_mul_f32 v174, v174, v11
    v_mul_f32 v175, v175, v11
    v_mul_f32 v176, v176, v11
    v_mul_f32 v177, v177, v11
    v_mul_f32 v178, v178, v11
    v_mul_f32 v179, v179, v11
    v_cvt_pk_bf16_f32 v218, v220, v221
    v_mul_f32 v222, v222, v12
    v_mul_f32 v223, v223, v12
    v_mul_f32 v224, v224, v12
    v_mul_f32 v225, v225, v12
    v_mul_f32 v226, v226, v12
    v_mul_f32 v227, v227, v12
    v_cvt_pk_bf16_f32 v171, v174, v175
    v_cvt_pk_bf16_f32 v172, v176, v177
    v_cvt_pk_bf16_f32 v173, v178, v179
    v_cvt_pk_bf16_f32 v219, v222, v223
    v_cvt_pk_bf16_f32 v220, v224, v225
    v_cvt_pk_bf16_f32 v221, v226, v227
    ds_write_b128 v4, v[168:171] offset:49152
    ds_write_b64 v5, v[172:173] offset:49152
    ds_write_b128 v4, v[216:219] offset:50688
    ds_write_b64 v5, v[220:221] offset:50688
L_slow_RB_ret:
    v_mov_b32 v11, s79
    v_mov_b32 v12, 3
    ds_write_b32 v11, v12
    s_branch L_second_done
L_half:
    s_or_b32 s73, s66, s68
    s_or_b32 s73, s73, s65
    s_or_b32 s73, s73, s67
    s_cmp_eq_u32 s73, 0
    s_cbranch_scc1 L_nomask3
    v_mbcnt_lo_u32_b32 v12, -1, 0
    v_mbcnt_hi_u32_b32 v12, -1, v12
    v_bfe_u32 v11, v12, 2, 1
    v_and_b32 v11, s66, v11
    v_cmp_eq_u32 vcc, 1, v11
    v_mov_b32 v11, 0x0000ffff
    v_mov_b32 v13, 0xffff0000
    v_cndmask_b32 v11, v11, v13, vcc
    v_lshrrev_b32 v12, 5, v12
    v_cmp_eq_u32 vcc, s38, v12
    s_nop 1
    v_cndmask_b32 v13, 0, v11, vcc
    v_and_b32 v94, 0x3f803f80, v13
    v_mov_b32 v95, v94
    v_not_b32 v13, v13
    v_and_b32 v110, 0xc310c310, v13
    v_and_b32 v111, 0xbe8abe8a, v13
    v_cmp_eq_u32 vcc, s39, v12
    s_nop 1
    v_cndmask_b32 v13, 0, v11, vcc
    v_and_b32 v102, 0x3f803f80, v13
    v_mov_b32 v103, v102
    v_not_b32 v13, v13
    v_and_b32 v118, 0xc310c310, v13
    v_and_b32 v119, 0xbe8abe8a, v13
    s_nop 1
L_nomask3:
    s_mul_i32 s73, s36, 6144
    s_sub_u32 s74, 6144, s73
    s_sub_u32 s73, s73, 0
    v_add_u32 v96, s74, v2
    v_add_u32 v97, s74, v3
    v_add_u32 v2, s73, v2
    v_add_u32 v3, s73, v3
    s_lshl_b32 s73, s36, 9
    v_add_u32 v98, s73, v0
    s_cmp_eq_u32 s71, 0
    s_cbranch_scc1 L_slow_RH
    ds_read_b128 v[168:171], v6 offset:0
    ds_read_b64_tr_b16 v[184:185], v7 offset:0
    ds_read_b64_tr_b16 v[186:187], v7 offset:1536
    ds_read_b64_tr_b16 v[188:189], v7 offset:8
    ds_read_b64_tr_b16 v[190:191], v7 offset:1544
    ds_read_b64_tr_b16 v[192:193], v7 offset:64
    ds_read_b64_tr_b16 v[194:195], v7 offset:1600
    ds_read_b64_tr_b16 v[196:197], v7 offset:72
    ds_read_b64_tr_b16 v[198:199], v7 offset:1608
    ds_read_b64_tr_b16 v[180:181], v7 offset:128
    ds_read_b64_tr_b16 v[182:183], v7 offset:1664
    ds_read_b128 v[172:175], v6 offset:16
    ds_read_b128 v[176:179], v6 offset:32
    ds_read_b128 v[232:235], v2 offset:0
    ds_read_b128 v[236:239], v3 offset:0
    s_waitcnt lgkmcnt(12)
    v_mfma_f32_16x16x32_bf16 v[216:219], v[184:187], v[168:171], 0
    ds_read_b64_tr_b16 v[184:185], v7 offset:136
    ds_read_b64_tr_b16 v[186:187], v7 offset:1672
    s_waitcnt lgkmcnt(12)
    v_mfma_f32_16x16x32_bf16 v[220:223], v[188:191], v[168:171], 0
    ds_read_b64_tr_b16 v[188:189], v7 offset:768
    ds_read_b64_tr_b16 v[190:191], v7 offset:2304
    s_waitcnt lgkmcnt(12)
    v_mfma_f32_16x16x32_bf16 v[224:227], v[192:195], v[168:171], 0
    ds_read_b64_tr_b16 v[192:193], v7 offset:776
    ds_read_b64_tr_b16 v[194:195], v7 offset:2312
    s_waitcnt lgkmcnt(12)
    v_mfma_f32_16x16x32_bf16 v[228:231], v[196:199], v[168:171], 0
    ds_read_b64_tr_b16 v[196:197], v7 offset:832
    ds_read_b64_tr_b16 v[198:199], v7 offset:2368
    s_waitcnt lgkmcnt(12)
    v_mfma_f32_16x16x32_bf16 v[200:203], v[180:183], v[168:171], 0
    ds_read_b64_tr_b16 v[180:181], v7 offset:840
    ds_read_b64_tr_b16 v[182:183], v7 offset:2376
    s_waitcnt lgkmcnt(11)
    v_mfma_f32_32x32x16_bf16 v[136:151], v[16:19], v[232:235], 0
    ds_read_b128 v[240:243], v2 offset:64
    ds_read_b128 v[244:247], v3 offset:64
    ds_read_b128 v[248:251], v2 offset:128
    v_mfma_f32_32x32x16_bf16 v[152:167], v[40:43], v[232:235], 0
    ds_read_b128 v[252:255], v3 offset:128
    s_waitcnt lgkmcnt(14)
    v_mfma_f32_32x32x16_bf16 v[136:151], v[20:23], v[236:239], v[136:151]
    s_waitcnt lgkmcnt(12)
    v_mfma_f32_16x16x32_bf16 v[204:207], v[184:187], v[168:171], 0
    ds_read_b64_tr_b16 v[184:185], v7 offset:896
    ds_read_b64_tr_b16 v[186:187], v7 offset:2432
    s_waitcnt lgkmcnt(12)
    v_mfma_f32_16x16x32_bf16 v[216:219], v[188:191], v[172:175], v[216:219]
    ds_read_b64_tr_b16 v[188:189], v7 offset:904
    ds_read_b64_tr_b16 v[190:191], v7 offset:2440
    s_waitcnt lgkmcnt(12)
    v_mfma_f32_16x16x32_bf16 v[220:223], v[192:195], v[172:175], v[220:223]
    ds_read_b64_tr_b16 v[192:193], v7 offset:3072
    ds_read_b64_tr_b16 v[194:195], v7 offset:3840
    s_waitcnt lgkmcnt(12)
    v_mfma_f32_16x16x32_bf16 v[224:227], v[196:199], v[172:175], v[224:227]
    ds_read_b64_tr_b16 v[196:197], v7 offset:3080
    ds_read_b64_tr_b16 v[198:199], v7 offset:3848
    s_waitcnt lgkmcnt(12)
    v_mfma_f32_16x16x32_bf16 v[228:231], v[180:183], v[172:175], v[228:231]
    ds_read_b64_tr_b16 v[180:181], v7 offset:3136
    ds_read_b64_tr_b16 v[182:183], v7 offset:3904
    v_mfma_f32_32x32x16_bf16 v[152:167], v[44:47], v[236:239], v[152:167]
    s_waitcnt lgkmcnt(13)
    v_mfma_f32_32x32x16_bf16 v[136:151], v[24:27], v[240:243], v[136:151]
    v_mfma_f32_32x32x16_bf16 v[152:167], v[48:51], v[240:243], v[152:167]
    s_waitcnt lgkmcnt(8)
    v_mfma_f32_16x16x32_bf16 v[200:203], v[184:187], v[172:175], v[200:203]
    ds_read_b64_tr_b16 v[184:185], v7 offset:3144
    ds_read_b64_tr_b16 v[186:187], v7 offset:3912
    s_waitcnt lgkmcnt(8)
    v_mfma_f32_16x16x32_bf16 v[204:207], v[188:191], v[172:175], v[204:207]
    ds_read_b64_tr_b16 v[188:189], v7 offset:3200
    ds_read_b64_tr_b16 v[190:191], v7 offset:3968
    s_waitcnt lgkmcnt(8)
    v_mfma_f32_16x16x32_bf16 v[216:219], v[192:195], v[176:179], v[216:219]
    ds_read_b64_tr_b16 v[192:193], v7 offset:3208
    ds_read_b64_tr_b16 v[194:195], v7 offset:3976
    s_waitcnt lgkmcnt(8)
    v_mfma_f32_16x16x32_bf16 v[220:223], v[196:199], v[176:179], v[220:223]
    s_waitcnt lgkmcnt(6)
    v_mfma_f32_16x16x32_bf16 v[224:227], v[180:183], v[176:179], v[224:227]
    v_mul_f32 v14, v216, v216
    v_add_f32 v13, v216, v217
    v_mfma_f32_32x32x16_bf16 v[136:151], v[28:31], v[244:247], v[136:151]
    v_fmac_f32 v14, v217, v217
    v_add_f32 v13, v13, v218
    v_fmac_f32 v14, v218, v218
    v_add_f32 v13, v13, v219
    v_fmac_f32 v14, v219, v219
    v_add_f32 v13, v13, v220
    v_mfma_f32_32x32x16_bf16 v[152:167], v[52:55], v[244:247], v[152:167]
    v_fmac_f32 v14, v220, v220
    v_add_f32 v13, v13, v221
    v_fmac_f32 v14, v221, v221
    v_add_f32 v13, v13, v222
    v_fmac_f32 v14, v222, v222
    v_add_f32 v13, v13, v223
    v_mfma_f32_32x32x16_bf16 v[136:151], v[32:35], v[248:251], v[136:151]
    v_fmac_f32 v14, v223, v223
    v_add_f32 v13, v13, v224
    v_fmac_f32 v14, v224, v224
    v_add_f32 v13, v13, v225
    v_fmac_f32 v14, v225, v225
    v_add_f32 v13, v13, v226
    s_waitcnt lgkmcnt(4)
    v_mfma_f32_16x16x32_bf16 v[228:231], v[184:187], v[176:179], v[228:231]
    v_fmac_f32 v14, v226, v226
    v_add_f32 v13, v13, v227
    s_waitcnt lgkmcnt(2)
    v_mfma_f32_16x16x32_bf16 v[200:203], v[188:191], v[176:179], v[200:203]
    v_fmac_f32 v14, v227, v227
    s_waitcnt lgkmcnt(0)
    v_mfma_f32_16x16x32_bf16 v[204:207], v[192:195], v[176:179], v[204:207]
    v_add_f32 v13, v13, v228
    v_fmac_f32 v14, v228, v228
    v_mfma_f32_32x32x16_bf16 v[168:183], v[232:235], v[64:67], 0
    v_add_f32 v13, v13, v229
    v_fmac_f32 v14, v229, v229
    v_add_f32 v13, v13, v230
    v_fmac_f32 v14, v230, v230
    v_add_f32 v13, v13, v231
    v_fmac_f32 v14, v231, v231
    v_mfma_f32_32x32x16_bf16 v[168:183], v[236:239], v[68:71], v[168:183]
    v_add_f32 v13, v13, v200
    v_fmac_f32 v14, v200, v200
    v_add_f32 v13, v13, v201
    v_fmac_f32 v14, v201, v201
    v_add_f32 v13, v13, v202
    v_fmac_f32 v14, v202, v202
    v_mfma_f32_32x32x16_bf16 v[152:167], v[56:59], v[248:251], v[152:167]
    v_add_f32 v13, v13, v203
    v_fmac_f32 v14, v203, v203
    v_add_f32 v13, v13, v204
    v_fmac_f32 v14, v204, v204
    v_add_f32 v13, v13, v205
    v_fmac_f32 v14, v205, v205
    v_mfma_f32_32x32x16_bf16 v[168:183], v[240:243], v[72:75], v[168:183]
    v_add_f32 v13, v13, v206
    v_fmac_f32 v14, v206, v206
    v_add_f32 v13, v13, v207
    v_fmac_f32 v14, v207, v207
    ds_read_b128 v[232:235], v96 offset:0
    ds_read_b128 v[236:239], v97 offset:0
    v_mfma_f32_32x32x16_bf16 v[136:151], v[36:39], v[252:255], v[136:151]
    v_permlane32_swap_b32 v13, v14
    v_add_f32 v13, v13, v14
    v_mov_b32 v14, v13
    ds_read_b128 v[240:243], v96 offset:64
    v_mfma_f32_32x32x16_bf16 v[152:167], v[60:63], v[252:255], v[152:167]
    v_permlane16_swap_b32 v13, v14
    v_add_f32 v13, v13, v14
    v_mov_b32 v14, v13
    s_nop 0
    v_fmaak_f32 v11, v136, v136, 0x2b0cbccc
    v_fmac_f32 v11, v137, v137
    v_mfma_f32_32x32x16_bf16 v[168:183], v[244:247], v[76:79], v[168:183]
    v_permlane32_swap_b32 v13, v14
    v_mul_f32 v13, s82, v13
    v_fma_f32 v1, -v13, v13, s83
    v_fma_f32 v14, v14, s82, v1
    v_rsq_f32 v14, v14
    v_mfma_f32_32x32x16_bf16 v[168:183], v[248:251], v[80:83], v[168:183]
    v_mul_f32 v13, -v13, v14
    v_fma_f32 v200, v200, v14, v13
    v_fma_f32 v201, v201, v14, v13
    v_fma_f32 v202, v202, v14, v13
    v_fma_f32 v203, v203, v14, v13
    v_cvt_pk_bf16_f32 v200, v200, v201
    v_mfma_f32_32x32x16_bf16 v[168:183], v[252:255], v[84:87], v[168:183]
    v_fma_f32 v204, v204, v14, v13
    v_fma_f32 v205, v205, v14, v13
    v_fma_f32 v206, v206, v14, v13
    v_fma_f32 v207, v207, v14, v13
    v_cvt_pk_bf16_f32 v201, v202, v203
    ds_read_b128 v[244:247], v97 offset:64
    v_cvt_pk_bf16_f32 v202, v204, v205
    v_cvt_pk_bf16_f32 v203, v206, v207
    buffer_store_dwordx4 v[200:203], v8, s[20:23], 0 offen offset:128 sc1 nt
    s_waitcnt lgkmcnt(3)
    s_nop 0
    v_mfma_f32_32x32x16_bf16 v[200:215], v[40:43], v[232:235], 0
    v_fmaak_f32 v12, v152, v152, 0x2b0cbccc
    ds_read_b128 v[248:251], v96 offset:128
    v_fmac_f32 v12, v153, v153
    v_fmac_f32 v11, v138, v138
    v_fmac_f32 v12, v154, v154
    v_fmac_f32 v11, v139, v139
    s_waitcnt lgkmcnt(3)
    v_mfma_f32_32x32x16_bf16 v[200:215], v[44:47], v[236:239], v[200:215]
    v_fmac_f32 v12, v155, v155
    v_fmac_f32 v11, v140, v140
    v_fmac_f32 v12, v156, v156
    v_fmac_f32 v11, v141, v141
    v_fmac_f32 v12, v157, v157
    ds_read_b128 v[252:255], v97 offset:128
    s_waitcnt lgkmcnt(3)
    v_mfma_f32_32x32x16_bf16 v[200:215], v[48:51], v[240:243], v[200:215]
    v_fmac_f32 v11, v142, v142
    v_fmac_f32 v12, v158, v158
    v_fmac_f32 v11, v143, v143
    v_fmac_f32 v12, v159, v159
    v_fmac_f32 v11, v144, v144
    v_fmac_f32 v12, v160, v160
    v_fmac_f32 v11, v145, v145
    v_fmac_f32 v12, v161, v161
    v_fmac_f32 v11, v146, v146
    v_fmac_f32 v12, v162, v162
    v_fmac_f32 v11, v147, v147
    v_fmac_f32 v12, v163, v163
    v_fma_f32 v216, v216, v14, v13
    s_waitcnt lgkmcnt(2)
    v_mfma_f32_32x32x16_bf16 v[200:215], v[52:55], v[244:247], v[200:215]
    v_permlane32_swap_b32 v11, v12
    v_add_f32 v11, v11, v12
    v_rsq_f32 v11, v11
    v_fma_f32 v217, v217, v14, v13
    s_waitcnt lgkmcnt(1)
    v_mfma_f32_32x32x16_bf16 v[200:215], v[56:59], v[248:251], v[200:215]
    v_mul_f32 v11, v11, v10
    v_mov_b32 v12, v11
    v_fma_f32 v224, v224, v14, v13
    v_fma_f32 v225, v225, v14, v13
    v_permlane32_swap_b32 v11, v12
    v_mul_f32 v136, v136, v11
    v_mul_f32 v137, v137, v11
    v_mul_f32 v138, v138, v11
    s_waitcnt lgkmcnt(0)
    v_mfma_f32_32x32x16_bf16 v[200:215], v[60:63], v[252:255], v[200:215]
    v_mul_f32 v139, v139, v11
    v_mul_f32 v140, v140, v11
    v_mul_f32 v141, v141, v11
    v_mul_f32 v142, v142, v11
    v_mul_f32 v143, v143, v11
    v_mul_f32 v144, v144, v11
    v_mul_f32 v145, v145, v11
    v_mul_f32 v146, v146, v11
    v_mul_f32 v147, v147, v11
    v_cvt_pk_bf16_f32 v88, v136, v137
    v_cvt_pk_bf16_f32 v89, v138, v139
    v_cvt_pk_bf16_f32 v90, v140, v141
    v_cvt_pk_bf16_f32 v91, v142, v143
    v_cvt_pk_bf16_f32 v92, v144, v145
    v_cvt_pk_bf16_f32 v93, v146, v147
    v_fma_f32 v218, v218, v14, v13
    v_fma_f32 v219, v219, v14, v13
    v_cvt_pk_bf16_f32 v216, v216, v217
    v_fma_f32 v226, v226, v14, v13
    v_fma_f32 v227, v227, v14, v13
    v_cvt_pk_bf16_f32 v224, v224, v225
    ds_read_b128 v[136:139], v0 offset:448
    ds_read_b128 v[140:143], v0 offset:384
    ds_read_b128 v[144:147], v0 offset:320
    ds_read_b128 v[148:151], v0 offset:256
    v_fma_f32 v220, v220, v14, v13
    v_fma_f32 v221, v221, v14, v13
    v_fma_f32 v222, v222, v14, v13
    v_fma_f32 v223, v223, v14, v13
    v_cvt_pk_bf16_f32 v217, v218, v219
    v_fma_f32 v228, v228, v14, v13
    v_fma_f32 v229, v229, v14, v13
    v_fma_f32 v230, v230, v14, v13
    v_fma_f32 v231, v231, v14, v13
    v_cvt_pk_bf16_f32 v225, v226, v227
    v_cvt_pk_bf16_f32 v218, v220, v221
    v_cvt_pk_bf16_f32 v219, v222, v223
    v_cvt_pk_bf16_f32 v226, v228, v229
    v_cvt_pk_bf16_f32 v227, v230, v231
    buffer_store_dwordx4 v[216:219], v8, s[20:23], 0 offen offset:0 sc1 nt
    buffer_store_dwordx4 v[224:227], v8, s[20:23], 0 offen offset:64 sc1 nt
    s_nop 1
    v_mfma_f32_32x32x16_bf16 v[216:231], v[232:235], v[64:67], 0
    v_fmaak_f32 v14, v200, v200, 0x2b0cbccc
    v_fmac_f32 v14, v201, v201
    v_fmac_f32 v14, v202, v202
    v_mul_f32 v152, v152, v12
    v_mul_f32 v153, v153, v12
    v_mul_f32 v154, v154, v12
    v_mfma_f32_32x32x16_bf16 v[216:231], v[236:239], v[68:71], v[216:231]
    v_mul_f32 v155, v155, v12
    v_mul_f32 v156, v156, v12
    v_mul_f32 v157, v157, v12
    v_mul_f32 v158, v158, v12
    v_mul_f32 v159, v159, v12
    v_mul_f32 v160, v160, v12
    v_mfma_f32_32x32x16_bf16 v[216:231], v[240:243], v[72:75], v[216:231]
    v_mul_f32 v161, v161, v12
    v_mul_f32 v162, v162, v12
    v_mul_f32 v163, v163, v12
    v_fmac_f32 v14, v203, v203
    v_cvt_pk_bf16_f32 v104, v152, v153
    v_cvt_pk_bf16_f32 v105, v154, v155
    v_mfma_f32_32x32x16_bf16 v[216:231], v[244:247], v[76:79], v[216:231]
    v_cvt_pk_bf16_f32 v106, v156, v157
    v_cvt_pk_bf16_f32 v107, v158, v159
    v_cvt_pk_bf16_f32 v108, v160, v161
    v_cvt_pk_bf16_f32 v109, v162, v163
    v_fmac_f32 v14, v204, v204
    ds_read_b128 v[152:155], v98 offset:192
    s_waitcnt lgkmcnt(1)
    v_mfma_f32_32x32x16_bf16 v[136:151], v[104:107], v[88:91], v[136:151]
    ds_read_b128 v[156:159], v98 offset:128
    ds_read_b128 v[160:163], v98 offset:64
    ds_read_b128 v[164:167], v98 offset:0
    v_fmac_f32 v14, v205, v205
    v_fmac_f32 v14, v206, v206
    v_fmac_f32 v14, v207, v207
    v_mfma_f32_32x32x16_bf16 v[136:151], v[108:111], v[92:95], v[136:151]
    v_fmac_f32 v14, v208, v208
    v_fmac_f32 v14, v209, v209
    v_fmac_f32 v14, v210, v210
    v_fmac_f32 v14, v211, v211
    v_mov_b32 v13, v14
    s_mov_b64 exec, s[76:77]
    v_cvt_pk_bf16_f32 v120, v168, v169
    v_cvt_pk_bf16_f32 v121, v170, v171
    v_cvt_pk_bf16_f32 v122, v172, v173
    v_cvt_pk_bf16_f32 v123, v174, v175
    v_cvt_pk_bf16_f32 v124, v176, v177
    v_cvt_pk_bf16_f32 v125, v178, v179
    v_cvt_pk_bf16_f32 v126, v180, v181
    v_cvt_pk_bf16_f32 v127, v182, v183
    s_mov_b64 exec, -1
    v_mfma_f32_32x32x16_bf16 v[216:231], v[248:251], v[80:83], v[216:231]
    v_permlane32_swap_b32 v13, v14
    v_add_f32 v14, v13, v14
    v_rsq_f32 v14, v14
    v_exp_f32 v136, v136
    v_mfma_f32_32x32x16_bf16 v[216:231], v[252:255], v[84:87], v[216:231]
    v_mul_f32 v200, v200, v14
    v_mul_f32 v201, v201, v14
    v_mul_f32 v202, v202, v14
    v_mul_f32 v203, v203, v14
    v_mul_f32 v204, v204, v14
    v_mul_f32 v205, v205, v14
    v_mul_f32 v206, v206, v14
    v_mul_f32 v207, v207, v14
    v_cvt_pk_bf16_f32 v112, v200, v201
    v_cvt_pk_bf16_f32 v113, v202, v203
    v_cvt_pk_bf16_f32 v114, v204, v205
    v_cvt_pk_bf16_f32 v115, v206, v207
    v_mul_f32 v208, v208, v14
    v_mul_f32 v209, v209, v14
    s_waitcnt lgkmcnt(0)
    v_mfma_f32_32x32x16_bf16 v[152:167], v[112:115], v[88:91], v[152:167]
    v_mul_f32 v210, v210, v14
    v_mul_f32 v211, v211, v14
    v_exp_f32 v137, v137
    v_cvt_pk_bf16_f32 v116, v208, v209
    v_cvt_pk_bf16_f32 v117, v210, v211
    v_exp_f32 v138, v138
    s_nop 0
    v_mfma_f32_32x32x16_bf16 v[152:167], v[116:119], v[92:95], v[152:167]
    v_exp_f32 v139, v139
    v_exp_f32 v140, v140
    v_exp_f32 v141, v141
    v_exp_f32 v142, v142
    v_exp_f32 v143, v143
    v_cvt_pk_bf16_f32 v136, v136, v137
    v_cvt_pk_bf16_f32 v137, v138, v139
    v_cvt_pk_bf16_f32 v138, v140, v141
    v_cvt_pk_bf16_f32 v139, v142, v143
    s_mov_b64 exec, s[76:77]
    v_cvt_pk_bf16_f32 v128, v216, v217
    v_cvt_pk_bf16_f32 v129, v218, v219
    v_cvt_pk_bf16_f32 v130, v220, v221
    v_cvt_pk_bf16_f32 v131, v222, v223
    v_cvt_pk_bf16_f32 v132, v224, v225
    v_cvt_pk_bf16_f32 v133, v226, v227
    v_cvt_pk_bf16_f32 v134, v228, v229
    v_cvt_pk_bf16_f32 v135, v230, v231
    s_mov_b64 exec, -1
    v_mfma_f32_32x32x16_bf16 v[168:183], v[120:123], v[136:139], 0
    v_exp_f32 v144, v144
    v_exp_f32 v145, v145
    v_exp_f32 v146, v146
    v_exp_f32 v147, v147
    v_exp_f32 v148, v148
    v_exp_f32 v149, v149
    v_exp_f32 v150, v150
    v_exp_f32 v151, v151
    v_cvt_pk_bf16_f32 v140, v144, v145
    v_cvt_pk_bf16_f32 v141, v146, v147
    v_cvt_pk_bf16_f32 v142, v148, v149
    v_cvt_pk_bf16_f32 v143, v150, v151
    v_exp_f32 v152, v152
    s_nop 0
    v_mfma_f32_32x32x16_bf16 v[168:183], v[124:127], v[140:143], v[168:183]
    v_exp_f32 v153, v153
    v_exp_f32 v154, v154
    v_exp_f32 v155, v155
    v_exp_f32 v156, v156
    v_exp_f32 v157, v157
    v_exp_f32 v158, v158
    v_exp_f32 v159, v159
    v_cvt_pk_bf16_f32 v152, v152, v153
    v_cvt_pk_bf16_f32 v153, v154, v155
    v_cvt_pk_bf16_f32 v154, v156, v157
    v_cvt_pk_bf16_f32 v155, v158, v159
    v_exp_f32 v160, v160
    s_nop 0
    v_mfma_f32_32x32x16_bf16 v[168:183], v[128:131], v[152:155], v[168:183]
    v_exp_f32 v161, v161
    v_exp_f32 v162, v162
    v_exp_f32 v163, v163
    v_exp_f32 v164, v164
    v_exp_f32 v165, v165
    v_exp_f32 v166, v166
    v_exp_f32 v167, v167
    v_cvt_pk_bf16_f32 v156, v160, v161
    v_cvt_pk_bf16_f32 v157, v162, v163
    v_cvt_pk_bf16_f32 v158, v164, v165
    v_cvt_pk_bf16_f32 v159, v166, v167
    s_nop 1
    v_mfma_f32_32x32x16_bf16 v[168:183], v[132:135], v[156:159], v[168:183]
    s_nop 11
    v_rcp_f32 v11, v180
    s_nop 0
    v_mul_f32 v168, v168, v11
    v_mul_f32 v169, v169, v11
    v_cvt_pk_bf16_f32 v168, v168, v169
    v_mul_f32 v170, v170, v11
    v_mul_f32 v171, v171, v11
    v_cvt_pk_bf16_f32 v169, v170, v171
    v_mul_f32 v172, v172, v11
    v_mul_f32 v173, v173, v11
    v_cvt_pk_bf16_f32 v170, v172, v173
    v_mul_f32 v174, v174, v11
    v_mul_f32 v175, v175, v11
    v_mul_f32 v176, v176, v11
    v_mul_f32 v177, v177, v11
    v_mul_f32 v178, v178, v11
    v_mul_f32 v179, v179, v11
    v_cvt_pk_bf16_f32 v171, v174, v175
    v_cvt_pk_bf16_f32 v172, v176, v177
    v_cvt_pk_bf16_f32 v173, v178, v179
    ds_write_b128 v4, v[168:171] offset:49152
    ds_write_b64 v5, v[172:173] offset:49152
L_slow_RH_ret:
    v_mov_b32 v11, s79
    v_mov_b32 v12, 3
    ds_write_b32 v11, v12
    s_cmp_ge_u32 s60, 2
    s_cbranch_scc1 L_end
    s_waitcnt lgkmcnt(0)
    s_nop 0
L_second_done:
    v_add_u32 v6, 49152, v6
    v_mov_b32 v8, v9
L_poll3:
    ds_read_b32 v13, v15
    s_waitcnt lgkmcnt(0)
    v_cmp_gt_u32 vcc, 3, v13
    s_cbranch_vccz L_poll3_ok
    s_sub_u32 s80, s80, 1
    s_cbranch_scc0 L_poll3
L_poll3_ok:
    s_waitcnt lgkmcnt(0)
    s_nop 2
L_last:
    s_waitcnt lgkmcnt(0)
    ds_read_b128 v[168:171], v6 offset:0
    ds_read_b64_tr_b16 v[184:185], v7 offset:0
    ds_read_b64_tr_b16 v[186:187], v7 offset:1536
    ds_read_b64_tr_b16 v[188:189], v7 offset:8
    ds_read_b64_tr_b16 v[190:191], v7 offset:1544
    ds_read_b64_tr_b16 v[192:193], v7 offset:64
    ds_read_b64_tr_b16 v[194:195], v7 offset:1600
    ds_read_b64_tr_b16 v[196:197], v7 offset:72
    ds_read_b64_tr_b16 v[198:199], v7 offset:1608
    ds_read_b128 v[172:175], v6 offset:16
    ds_read_b64_tr_b16 v[140:141], v7 offset:768
    ds_read_b64_tr_b16 v[142:143], v7 offset:2304
    ds_read_b128 v[176:179], v6 offset:32
    ds_read_b64_tr_b16 v[180:181], v7 offset:128
    ds_read_b64_tr_b16 v[182:183], v7 offset:1664
    s_waitcnt lgkmcnt(12)
    v_mfma_f32_16x16x32_bf16 v[216:219], v[184:187], v[168:171], 0
    ds_read_b64_tr_b16 v[164:165], v7 offset:3072
    ds_read_b64_tr_b16 v[166:167], v7 offset:3840
    s_waitcnt lgkmcnt(12)
    v_mfma_f32_16x16x32_bf16 v[220:223], v[188:191], v[168:171], 0
    ds_read_b64_tr_b16 v[144:145], v7 offset:776
    ds_read_b64_tr_b16 v[146:147], v7 offset:2312
    s_waitcnt lgkmcnt(12)
    v_mfma_f32_16x16x32_bf16 v[224:227], v[192:195], v[168:171], 0
    ds_read_b64_tr_b16 v[184:185], v7 offset:3080
    ds_read_b64_tr_b16 v[186:187], v7 offset:3848
    s_waitcnt lgkmcnt(12)
    v_mfma_f32_16x16x32_bf16 v[228:231], v[196:199], v[168:171], 0
    ds_read_b64_tr_b16 v[148:149], v7 offset:832
    ds_read_b64_tr_b16 v[150:151], v7 offset:2368
    s_waitcnt lgkmcnt(11)
    v_mfma_f32_16x16x32_bf16 v[216:219], v[140:143], v[172:175], v[216:219]
    ds_read_b64_tr_b16 v[188:189], v7 offset:3136
    ds_read_b64_tr_b16 v[190:191], v7 offset:3904
    ds_read_b64_tr_b16 v[152:153], v7 offset:840
    ds_read_b64_tr_b16 v[154:155], v7 offset:2376
    ds_read_b64_tr_b16 v[192:193], v7 offset:3144
    s_waitcnt lgkmcnt(13)
    v_mfma_f32_16x16x32_bf16 v[200:203], v[180:183], v[168:171], 0
    ds_read_b64_tr_b16 v[194:195], v7 offset:3912
    ds_read_b64_tr_b16 v[156:157], v7 offset:896
    s_waitcnt lgkmcnt(13)
    v_mfma_f32_16x16x32_bf16 v[216:219], v[164:167], v[176:179], v[216:219]
    ds_read_b64_tr_b16 v[158:159], v7 offset:2432
    ds_read_b64_tr_b16 v[136:137], v7 offset:136
    s_waitcnt lgkmcnt(13)
    v_mfma_f32_16x16x32_bf16 v[220:223], v[144:147], v[172:175], v[220:223]
    ds_read_b64_tr_b16 v[138:139], v7 offset:1672
    ds_read_b64_tr_b16 v[196:197], v7 offset:3200
    s_waitcnt lgkmcnt(13)
    v_mfma_f32_16x16x32_bf16 v[220:223], v[184:187], v[176:179], v[220:223]
    ds_read_b64_tr_b16 v[198:199], v7 offset:3968
    ds_read_b64_tr_b16 v[160:161], v7 offset:904
    s_waitcnt lgkmcnt(13)
    v_mfma_f32_16x16x32_bf16 v[224:227], v[148:151], v[172:175], v[224:227]
    ds_read_b64_tr_b16 v[162:163], v7 offset:2440
    ds_read_b64_tr_b16 v[180:181], v7 offset:3208
    s_waitcnt lgkmcnt(13)
    v_mfma_f32_16x16x32_bf16 v[224:227], v[188:191], v[176:179], v[224:227]
    ds_read_b64_tr_b16 v[182:183], v7 offset:3976
    v_mul_f32 v14, v216, v216
    s_waitcnt lgkmcnt(12)
    v_mfma_f32_16x16x32_bf16 v[228:231], v[152:155], v[172:175], v[228:231]
    v_add_f32 v13, v216, v217
    v_fmac_f32 v14, v217, v217
    v_add_f32 v13, v13, v218
    v_fmac_f32 v14, v218, v218
    v_add_f32 v13, v13, v219
    v_fmac_f32 v14, v219, v219
    v_add_f32 v13, v13, v220
    v_fmac_f32 v14, v220, v220
    v_add_f32 v13, v13, v221
    v_fmac_f32 v14, v221, v221
    s_waitcnt lgkmcnt(10)
    v_mfma_f32_16x16x32_bf16 v[228:231], v[192:195], v[176:179], v[228:231]
    v_add_f32 v13, v13, v222
    v_fmac_f32 v14, v222, v222
    v_add_f32 v13, v13, v223
    s_waitcnt lgkmcnt(8)
    v_mfma_f32_16x16x32_bf16 v[200:203], v[156:159], v[172:175], v[200:203]
    v_fmac_f32 v14, v223, v223
    v_add_f32 v13, v13, v224
    s_waitcnt lgkmcnt(6)
    v_mfma_f32_16x16x32_bf16 v[204:207], v[136:139], v[168:171], 0
    v_fmac_f32 v14, v224, v224
    v_add_f32 v13, v13, v225
    s_waitcnt lgkmcnt(4)
    v_mfma_f32_16x16x32_bf16 v[200:203], v[196:199], v[176:179], v[200:203]
    v_fmac_f32 v14, v225, v225
    v_add_f32 v13, v13, v226
    s_waitcnt lgkmcnt(2)
    v_mfma_f32_16x16x32_bf16 v[204:207], v[160:163], v[172:175], v[204:207]
    v_fmac_f32 v14, v226, v226
    v_add_f32 v13, v13, v227
    s_waitcnt lgkmcnt(0)
    v_mfma_f32_16x16x32_bf16 v[204:207], v[180:183], v[176:179], v[204:207]
    v_fmac_f32 v14, v227, v227
    v_add_f32 v13, v13, v228
    v_fmac_f32 v14, v228, v228
    v_add_f32 v13, v13, v229
    v_fmac_f32 v14, v229, v229
    v_add_f32 v13, v13, v230
    v_fmac_f32 v14, v230, v230
    v_add_f32 v13, v13, v231
    v_fmac_f32 v14, v231, v231
    v_add_f32 v13, v13, v200
    v_fmac_f32 v14, v200, v200
    v_add_f32 v13, v13, v201
    v_fmac_f32 v14, v201, v201
    v_add_f32 v13, v13, v202
    v_fmac_f32 v14, v202, v202
    v_add_f32 v13, v13, v203
    v_fmac_f32 v14, v203, v203
    v_add_f32 v13, v13, v204
    v_fmac_f32 v14, v204, v204
    v_add_f32 v13, v13, v205
    v_fmac_f32 v14, v205, v205
    v_add_f32 v13, v13, v206
    v_fmac_f32 v14, v206, v206
    v_add_f32 v13, v13, v207
    v_fmac_f32 v14, v207, v207
    s_nop 1
    v_permlane32_swap_b32 v13, v14
    v_add_f32 v13, v13, v14
    v_mov_b32 v14, v13
    s_nop 1
    v_permlane16_swap_b32 v13, v14
    v_add_f32 v13, v13, v14
    v_mov_b32 v14, v13
    s_nop 1
    v_permlane32_swap_b32 v13, v14
    v_mul_f32 v13, s82, v13
    v_fma_f32 v1, -v13, v13, s83
    v_fma_f32 v14, v14, s82, v1
    v_rsq_f32 v14, v14
    s_nop 0
    v_mul_f32 v13, -v13, v14
    v_fma_f32 v216, v216, v14, v13
    v_fma_f32 v217, v217, v14, v13
    v_fma_f32 v224, v224, v14, v13
    v_fma_f32 v225, v225, v14, v13
    v_fma_f32 v200, v200, v14, v13
    v_fma_f32 v201, v201, v14, v13
    v_fma_f32 v218, v218, v14, v13
    v_fma_f32 v219, v219, v14, v13
    v_cvt_pk_bf16_f32 v216, v216, v217
    v_fma_f32 v226, v226, v14, v13
    v_fma_f32 v227, v227, v14, v13
    v_cvt_pk_bf16_f32 v224, v224, v225
    v_fma_f32 v202, v202, v14, v13
    v_fma_f32 v203, v203, v14, v13
    v_cvt_pk_bf16_f32 v200, v200, v201
    v_fma_f32 v220, v220, v14, v13
    v_fma_f32 v221, v221, v14, v13
    v_fma_f32 v222, v222, v14, v13
    v_fma_f32 v223, v223, v14, v13
    v_cvt_pk_bf16_f32 v217, v218, v219
    v_fma_f32 v228, v228, v14, v13
    v_fma_f32 v229, v229, v14, v13
    v_fma_f32 v230, v230, v14, v13
    v_fma_f32 v231, v231, v14, v13
    v_cvt_pk_bf16_f32 v225, v226, v227
    v_fma_f32 v204, v204, v14, v13
    v_fma_f32 v205, v205, v14, v13
    v_fma_f32 v206, v206, v14, v13
    v_fma_f32 v207, v207, v14, v13
    v_cvt_pk_bf16_f32 v201, v202, v203
    v_cvt_pk_bf16_f32 v218, v220, v221
    v_cvt_pk_bf16_f32 v219, v222, v223
    v_cvt_pk_bf16_f32 v226, v228, v229
    v_cvt_pk_bf16_f32 v227, v230, v231
    v_cvt_pk_bf16_f32 v202, v204, v205
    v_cvt_pk_bf16_f32 v203, v206, v207
    buffer_store_dwordx4 v[216:219], v8, s[20:23], 0 offen offset:0 sc1 nt
    buffer_store_dwordx4 v[224:227], v8, s[20:23], 0 offen offset:64 sc1 nt
    buffer_store_dwordx4 v[200:203], v8, s[20:23], 0 offen offset:128 sc1 nt
L_end:
    s_endpgm
L_fastend:
L_slow_RA:
    s_cmp_eq_u32 s69, 0
    s_cbranch_scc1 L_cx2_0
    s_add_u32 m0, s28, 0
    s_nop 0
    buffer_load_dwordx4 v187, s[8:11], 0 offen nt lds
L_cx2_0:
    v_and_b32 v202, 7, v192
    ds_read_b64_tr_b16 v[16:17], v104 offset:0
    s_cmp_eq_u32 s69, 0
    s_cbranch_scc1 L_cx2_1
    s_add_u32 m0, s28, 1024
    s_nop 0
    buffer_load_dwordx4 v188, s[8:11], 0 offen nt lds
L_cx2_1:
    ds_read_b64_tr_b16 v[18:19], v104 offset:2304
    ds_read_b64_tr_b16 v[40:41], v104 offset:192
    s_cmp_eq_u32 s69, 0
    s_cbranch_scc1 L_cx2_2
    s_add_u32 m0, s28, 2048
    s_nop 0
    buffer_load_dwordx4 v189, s[8:11], 0 offen nt lds
L_cx2_2:
    ds_read_b64_tr_b16 v[42:43], v104 offset:2496
    ds_read_b64_tr_b16 v[64:65], v104 offset:384
    s_cmp_lg_u32 s59, 0
    s_cbranch_scc1 L_cw2_0
    s_add_u32 m0, s30, 104448
    s_nop 0
    buffer_load_dwordx4 v194, s[16:19], s30 offen lds
L_cw2_0:
    ds_read_b64_tr_b16 v[66:67], v104 offset:2688
    ds_read_b128 v[232:235], v2 offset:24576
    v_sub_u32 v202, 7, v202
    v_lshl_add_u32 v202, v193, 2, v202
    v_and_b32 v203, 3, v202
    s_cmp_lg_u32 s59, 0
    s_cbranch_scc1 L_cw2_1
    s_add_u32 m0, s31, 104448
    s_nop 0
    buffer_load_dwordx4 v194, s[16:19], s31 offen lds
L_cw2_1:
    v_lshrrev_b32 v199, 1, v203
    v_mul_u32_u24 v203, 66, v203
    ds_read_b64_tr_b16 v[20:21], v104 offset:9216
    ds_read_b64_tr_b16 v[22:23], v104 offset:11520
    ds_read_b64_tr_b16 v[44:45], v104 offset:9408
    ds_read_b64_tr_b16 v[46:47], v104 offset:11712
    ds_read_b64_tr_b16 v[68:69], v104 offset:9600
    ds_read_b64_tr_b16 v[70:71], v104 offset:11904
    ds_read_b128 v[236:239], v3 offset:24576
    v_lshl_add_u32 v203, v199, 2, v203
    v_lshrrev_b32 v202, 2, v202
    v_add_u32 v203, v203, v202
    v_lshrrev_b32 v202, 3, v192
    s_mul_i32 s74, s59, 12288
    v_lshl_add_u32 v203, v202, 2, v203
    s_add_u32 s74, s74, 30720
    s_mul_i32 s75, s60, 3072
    s_mul_i32 s73, s60, 4192
    s_add_u32 s75, s75, s74
    v_mul_u32_u24 v202, 48, v192
    ds_read_b64_tr_b16 v[24:25], v104 offset:18432
    ds_read_b64_tr_b16 v[26:27], v104 offset:20736
    ds_read_b64_tr_b16 v[48:49], v104 offset:18624
    s_waitcnt lgkmcnt(10)
    v_mfma_f32_32x32x16_bf16 v[136:151], v[16:19], v[232:235], 0
    ds_read_b64_tr_b16 v[50:51], v104 offset:20928
    ds_read_b64_tr_b16 v[72:73], v104 offset:18816
    ds_read_b64_tr_b16 v[74:75], v104 offset:21120
    ds_read_b128 v[240:243], v2 offset:24640
    s_add_u32 s73, s73, 122880
    v_add_u32 v202, s75, v202
    v_mfma_f32_32x32x16_bf16 v[152:167], v[40:43], v[232:235], 0
    v_lshl_add_u32 v0, v203, 4, s73
    v_lshl_add_u32 v4, v193, 4, v202
    v_lshl_add_u32 v5, v193, 3, v202
    s_mul_i32 s78, s60, 768
    s_cmp_lg_u32 s59, 0
    s_cbranch_scc1 L_cw2_2
    s_add_u32 m0, s32, 104448
    s_nop 0
    buffer_load_dwordx4 v194, s[16:19], s32 offen lds
L_cw2_2:
    v_mfma_f32_32x32x16_bf16 v[168:183], v[232:235], v[64:67], 0
    s_add_u32 s78, s78, s74
    v_mul_u32_u24 v202, 48, v190
    v_mul_u32_u24 v203, 3072, v191
    v_add3_u32 v6, v202, v203, s78
    v_lshrrev_b32 v202, 2, v190
    ds_read_b64_tr_b16 v[28:29], v104 offset:27648
    s_waitcnt lgkmcnt(8)
    v_mfma_f32_32x32x16_bf16 v[136:151], v[20:23], v[236:239], v[136:151]
    ds_read_b64_tr_b16 v[30:31], v104 offset:29952
    ds_read_b64_tr_b16 v[52:53], v104 offset:27840
    ds_read_b64_tr_b16 v[54:55], v104 offset:30144
    ds_read_b64_tr_b16 v[76:77], v104 offset:28032
    ds_read_b64_tr_b16 v[78:79], v104 offset:30336
    ds_read_b128 v[244:247], v3 offset:24640
    v_mfma_f32_32x32x16_bf16 v[152:167], v[44:47], v[236:239], v[152:167]
    v_mad_u32_u24 v202, v191, 24, v202
    v_mul_u32_u24 v202, 192, v202
    v_and_b32 v203, 3, v190
    v_lshl_add_u32 v202, v203, 4, v202
    v_add_u32 v7, 104448, v202
    v_and_b32 v202, 7, v190
    v_mfma_f32_32x32x16_bf16 v[168:183], v[236:239], v[68:71], v[168:183]
    ds_read_b64_tr_b16 v[32:33], v104 offset:36864
    ds_read_b64_tr_b16 v[34:35], v104 offset:39168
    ds_read_b64_tr_b16 v[56:57], v104 offset:37056
    ds_read_b64_tr_b16 v[58:59], v104 offset:39360
    ds_read_b64_tr_b16 v[80:81], v104 offset:37248
    ds_read_b64_tr_b16 v[82:83], v104 offset:39552
    s_waitcnt lgkmcnt(13)
    v_mfma_f32_32x32x16_bf16 v[136:151], v[24:27], v[240:243], v[136:151]
    ds_read_b128 v[248:251], v2 offset:24704
    v_lshlrev_b32 v202, 2, v202
    s_cmp_lg_u32 s59, 0
    s_cbranch_scc1 L_cw2_3
    s_add_u32 m0, s33, 104448
    s_nop 0
    buffer_load_dwordx4 v194, s[16:19], s33 offen lds
L_cw2_3:
    v_mfma_f32_32x32x16_bf16 v[152:167], v[48:51], v[240:243], v[152:167]
    ds_read_b128 v[232:235], v2 offset:30720
    v_add_u32 v1, 139680, v202
    v_and_b32 v203, 7, v190
    v_lshrrev_b32 v202, 3, v190
    v_mul_u32_u24 v203, 192, v203
    v_mul_u32_u24 v202, 43008, v202
    v_mfma_f32_32x32x16_bf16 v[168:183], v[240:243], v[72:75], v[168:183]
    v_lshl_add_u32 v203, v191, 4, v203
    v_add_u32 v202, v202, v203
    ds_read_b64_tr_b16 v[36:37], v104 offset:46080
    ds_read_b64_tr_b16 v[38:39], v104 offset:48384
    ds_read_b64_tr_b16 v[60:61], v104 offset:46272
    ds_read_b64_tr_b16 v[62:63], v104 offset:48576
    s_waitcnt lgkmcnt(12)
    v_mfma_f32_32x32x16_bf16 v[136:151], v[28:31], v[244:247], v[136:151]
    ds_read_b64_tr_b16 v[84:85], v104 offset:46464
    ds_read_b64_tr_b16 v[86:87], v104 offset:48768
    ds_read_b128 v[252:255], v3 offset:24704
    ds_read_b128 v[236:239], v3 offset:30720
    v_bfe_u32 v203, v190, 2, 1
    v_mul_u32_u24 v203, 43008, v203
    v_mfma_f32_32x32x16_bf16 v[152:167], v[52:55], v[244:247], v[152:167]
    v_and_b32 v199, s65, v203
    v_sub_u32 v199, v202, v199
    v_add_u32 v8, s63, v199
    s_cmp_lg_u32 s59, 0
    s_cbranch_scc1 L_cw2_4
    s_add_u32 m0, s34, 104448
    s_nop 0
    buffer_load_dwordx4 v194, s[16:19], s34 offen lds
L_cw2_4:
    v_mfma_f32_32x32x16_bf16 v[168:183], v[244:247], v[76:79], v[168:183]
    ds_read_b128 v[240:243], v2 offset:30784
    v_and_b32 v199, s66, v203
    v_sub_u32 v199, v202, v199
    v_mov_b32 v202, s70
    v_mul_f32 v202, 0x3fb8aa3b, v202
    v_cmp_eq_u32 vcc, 0, v193
    s_nop 1
    v_cndmask_b32 v10, 1.0, v202, vcc
    s_waitcnt lgkmcnt(10)
    v_mfma_f32_32x32x16_bf16 v[136:151], v[32:35], v[248:251], v[136:151]
    ds_read_b128 v[244:247], v3 offset:30784
    v_add_u32 v9, s37, v199
    v_mov_b32 v13, s79
    v_mov_b32 v14, 1
    ds_write_b32 v13, v14 offset:32
    v_mov_b32 v120, 0x3f803f80
    v_mfma_f32_32x32x16_bf16 v[152:167], v[56:59], v[248:251], v[152:167]
    v_mov_b32 v121, 0x3f803f80
    v_mov_b32 v122, 0x3f803f80
    v_mov_b32 v123, 0x3f803f80
    v_mov_b32 v124, 0x3f803f80
    v_mov_b32 v125, 0x3f803f80
    v_mov_b32 v126, 0x3f803f80
    v_mfma_f32_32x32x16_bf16 v[168:183], v[248:251], v[80:83], v[168:183]
    ds_read_b128 v[248:251], v2 offset:30848
    v_mov_b32 v127, 0x3f803f80
    s_mov_b32 s76, 0x00ffffff
    s_mov_b32 s77, 0x00ffffff
    v_mov_b32 v128, 0x3f803f80
    v_mov_b32 v129, 0x3f803f80
    s_waitcnt lgkmcnt(12)
    v_mfma_f32_32x32x16_bf16 v[184:199], v[16:19], v[232:235], 0
    v_mov_b32 v130, 0x3f803f80
    v_mov_b32 v131, 0x3f803f80
    v_mov_b32 v132, 0x3f803f80
    v_mov_b32 v133, 0x3f803f80
    v_mov_b32 v134, 0x3f803f80
    v_mov_b32 v135, 0x3f803f80
    v_mfma_f32_32x32x16_bf16 v[200:215], v[40:43], v[232:235], 0
    s_mov_b32 s82, 0x3c2aaaab
    s_mov_b32 s83, 0x3727c5ac
    v_add_u32 v5, 32, v5
    s_mov_b32 s20, s56
    s_and_b32 s21, s57, 0xffff
    s_mov_b32 s22, 9633792
    s_waitcnt lgkmcnt(5)
    v_mfma_f32_32x32x16_bf16 v[136:151], v[36:39], v[252:255], v[136:151]
    s_mov_b32 s23, 0x00020000
    v_mfma_f32_32x32x16_bf16 v[152:167], v[60:63], v[252:255], v[152:167]
    s_nop 3
    v_fmaak_f32 v11, v136, v136, 0x2b0cbccc
    v_fmac_f32 v11, v137, v137
    v_fmac_f32 v11, v138, v138
    v_mfma_f32_32x32x16_bf16 v[168:183], v[252:255], v[84:87], v[168:183]
    ds_read_b128 v[252:255], v3 offset:30848
    v_fmac_f32 v11, v139, v139
    v_fmac_f32 v11, v140, v140
    s_nop 0
    v_fmaak_f32 v12, v152, v152, 0x2b0cbccc
    v_fmac_f32 v12, v153, v153
    v_fmac_f32 v12, v154, v154
    s_waitcnt lgkmcnt(5)
    v_mfma_f32_32x32x16_bf16 v[184:199], v[20:23], v[236:239], v[184:199]
    v_fmac_f32 v12, v155, v155
    v_fmac_f32 v12, v156, v156
    v_fmac_f32 v11, v141, v141
    v_fmac_f32 v12, v157, v157
    v_fmac_f32 v11, v142, v142
    v_fmac_f32 v12, v158, v158
    v_mfma_f32_32x32x16_bf16 v[200:215], v[44:47], v[236:239], v[200:215]
    v_fmac_f32 v11, v143, v143
    v_fmac_f32 v12, v159, v159
    v_fmac_f32 v11, v144, v144
    v_fmac_f32 v12, v160, v160
    v_fmac_f32 v11, v145, v145
    v_fmac_f32 v12, v161, v161
    s_waitcnt lgkmcnt(4)
    v_mfma_f32_32x32x16_bf16 v[184:199], v[24:27], v[240:243], v[184:199]
    v_fmac_f32 v11, v146, v146
    v_fmac_f32 v12, v162, v162
    v_fmac_f32 v11, v147, v147
    v_fmac_f32 v12, v163, v163
    ds_read_b128 v[148:151], v0 offset:256
    ds_read_b128 v[164:167], v0 offset:0
    v_mfma_f32_32x32x16_bf16 v[200:215], v[48:51], v[240:243], v[200:215]
    v_permlane32_swap_b32 v11, v12
    v_add_f32 v11, v11, v12
    v_rsq_f32 v11, v11
    s_mov_b64 exec, s[76:77]
    v_cvt_pk_bf16_f32 v120, v168, v169
    v_cvt_pk_bf16_f32 v121, v170, v171
    v_cvt_pk_bf16_f32 v122, v172, v173
    v_cvt_pk_bf16_f32 v123, v174, v175
    v_cvt_pk_bf16_f32 v124, v176, v177
    v_cvt_pk_bf16_f32 v125, v178, v179
    v_cvt_pk_bf16_f32 v126, v180, v181
    v_cvt_pk_bf16_f32 v127, v182, v183
    s_mov_b64 exec, -1
    s_waitcnt lgkmcnt(5)
    v_mfma_f32_32x32x16_bf16 v[184:199], v[28:31], v[244:247], v[184:199]
    v_mul_f32 v11, v11, v10
    v_mov_b32 v12, v11
    s_nop 1
    v_permlane32_swap_b32 v11, v12
    v_mfma_f32_32x32x16_bf16 v[200:215], v[52:55], v[244:247], v[200:215]
    v_mul_f32 v136, v136, v11
    v_mul_f32 v137, v137, v11
    v_mul_f32 v138, v138, v11
    v_mul_f32 v139, v139, v11
    v_mul_f32 v140, v140, v11
    v_mul_f32 v141, v141, v11
    s_waitcnt lgkmcnt(3)
    v_mfma_f32_32x32x16_bf16 v[184:199], v[32:35], v[248:251], v[184:199]
    v_mul_f32 v142, v142, v11
    v_mul_f32 v143, v143, v11
    v_mul_f32 v144, v144, v11
    v_mul_f32 v145, v145, v11
    v_mul_f32 v146, v146, v11
    v_mul_f32 v147, v147, v11
    v_mfma_f32_32x32x16_bf16 v[200:215], v[56:59], v[248:251], v[200:215]
    v_cvt_pk_bf16_f32 v88, v136, v137
    v_cvt_pk_bf16_f32 v89, v138, v139
    v_cvt_pk_bf16_f32 v90, v140, v141
    v_cvt_pk_bf16_f32 v91, v142, v143
    v_cvt_pk_bf16_f32 v92, v144, v145
    v_cvt_pk_bf16_f32 v93, v146, v147
    s_waitcnt lgkmcnt(2)
    v_mfma_f32_32x32x16_bf16 v[184:199], v[36:39], v[252:255], v[184:199]
    ds_read_b128 v[136:139], v0 offset:448
    ds_read_b128 v[140:143], v0 offset:384
    ds_read_b128 v[144:147], v0 offset:320
    v_mul_f32 v152, v152, v12
    v_mul_f32 v153, v153, v12
    v_mul_f32 v154, v154, v12
    v_mfma_f32_32x32x16_bf16 v[200:215], v[60:63], v[252:255], v[200:215]
    v_mul_f32 v155, v155, v12
    v_mul_f32 v156, v156, v12
    v_mul_f32 v157, v157, v12
    s_nop 0
    v_fmaak_f32 v13, v184, v184, 0x2b0cbccc
    v_fmac_f32 v13, v185, v185
    v_fmac_f32 v13, v186, v186
    v_mfma_f32_32x32x16_bf16 v[216:231], v[232:235], v[64:67], 0
    v_fmac_f32 v13, v187, v187
    v_fmac_f32 v13, v188, v188
    v_fmac_f32 v13, v189, v189
    s_nop 0
    v_fmaak_f32 v14, v200, v200, 0x2b0cbccc
    v_fmac_f32 v14, v201, v201
    v_fmac_f32 v14, v202, v202
    v_mfma_f32_32x32x16_bf16 v[216:231], v[236:239], v[68:71], v[216:231]
    v_fmac_f32 v14, v203, v203
    v_fmac_f32 v14, v204, v204
    v_fmac_f32 v14, v205, v205
    v_fmac_f32 v13, v190, v190
    v_fmac_f32 v14, v206, v206
    v_fmac_f32 v13, v191, v191
    v_mfma_f32_32x32x16_bf16 v[216:231], v[240:243], v[72:75], v[216:231]
    v_fmac_f32 v14, v207, v207
    v_fmac_f32 v13, v192, v192
    v_fmac_f32 v14, v208, v208
    v_fmac_f32 v13, v193, v193
    v_fmac_f32 v14, v209, v209
    v_fmac_f32 v13, v194, v194
    v_mfma_f32_32x32x16_bf16 v[216:231], v[244:247], v[76:79], v[216:231]
    v_fmac_f32 v14, v210, v210
    v_fmac_f32 v13, v195, v195
    v_fmac_f32 v14, v211, v211
    ds_read_b128 v[196:199], v0 offset:512
    v_mul_f32 v158, v158, v12
    v_permlane32_swap_b32 v13, v14
    v_mfma_f32_32x32x16_bf16 v[216:231], v[248:251], v[80:83], v[216:231]
    v_add_f32 v13, v13, v14
    v_rsq_f32 v13, v13
    v_mul_f32 v159, v159, v12
    v_mul_f32 v13, v13, v10
    v_mov_b32 v14, v13
    v_mfma_f32_32x32x16_bf16 v[216:231], v[252:255], v[84:87], v[216:231]
    s_nop 0
    v_permlane32_swap_b32 v13, v14
    v_mul_f32 v184, v184, v13
    v_mul_f32 v185, v185, v13
    v_mul_f32 v186, v186, v13
    v_mul_f32 v187, v187, v13
    v_mul_f32 v188, v188, v13
    v_mul_f32 v189, v189, v13
    v_mul_f32 v190, v190, v13
    v_mul_f32 v191, v191, v13
    v_mul_f32 v192, v192, v13
    v_mul_f32 v193, v193, v13
    v_mul_f32 v194, v194, v13
    v_mul_f32 v195, v195, v13
    v_cvt_pk_bf16_f32 v96, v184, v185
    v_cvt_pk_bf16_f32 v97, v186, v187
    v_cvt_pk_bf16_f32 v98, v188, v189
    v_cvt_pk_bf16_f32 v99, v190, v191
    v_cvt_pk_bf16_f32 v100, v192, v193
    v_cvt_pk_bf16_f32 v101, v194, v195
    ds_read_b128 v[184:187], v0 offset:704
    ds_read_b128 v[188:191], v0 offset:640
    ds_read_b128 v[192:195], v0 offset:576
    v_mul_f32 v160, v160, v12
    v_mul_f32 v161, v161, v12
    v_mul_f32 v162, v162, v12
    v_mul_f32 v163, v163, v12
    v_mul_f32 v200, v200, v14
    v_mul_f32 v201, v201, v14
    v_mul_f32 v202, v202, v14
    v_mul_f32 v203, v203, v14
    v_mul_f32 v204, v204, v14
    v_mul_f32 v205, v205, v14
    v_mul_f32 v206, v206, v14
    v_mul_f32 v207, v207, v14
    v_mul_f32 v208, v208, v14
    v_mul_f32 v209, v209, v14
    v_mul_f32 v210, v210, v14
    v_mul_f32 v211, v211, v14
    v_cvt_pk_bf16_f32 v104, v152, v153
    v_cvt_pk_bf16_f32 v105, v154, v155
    v_cvt_pk_bf16_f32 v106, v156, v157
    v_cvt_pk_bf16_f32 v107, v158, v159
    v_cvt_pk_bf16_f32 v108, v160, v161
    v_cvt_pk_bf16_f32 v109, v162, v163
    s_waitcnt lgkmcnt(4)
    v_mfma_f32_32x32x16_bf16 v[136:151], v[104:107], v[88:91], v[136:151]
    v_cvt_pk_bf16_f32 v112, v200, v201
    v_cvt_pk_bf16_f32 v113, v202, v203
    v_cvt_pk_bf16_f32 v114, v204, v205
    v_cvt_pk_bf16_f32 v115, v206, v207
    v_cvt_pk_bf16_f32 v116, v208, v209
    v_cvt_pk_bf16_f32 v117, v210, v211
    v_mfma_f32_32x32x16_bf16 v[136:151], v[108:111], v[92:95], v[136:151]
    ds_read_b128 v[152:155], v0 offset:192
    ds_read_b128 v[156:159], v0 offset:128
    ds_read_b128 v[160:163], v0 offset:64
    ds_read_b128 v[200:203], v0 offset:448
    ds_read_b128 v[204:207], v0 offset:384
    ds_read_b128 v[208:211], v0 offset:320
    s_waitcnt lgkmcnt(6)
    v_mfma_f32_32x32x16_bf16 v[184:199], v[104:107], v[96:99], v[184:199]
    ds_read_b128 v[212:215], v0 offset:256
    s_mov_b64 exec, s[76:77]
    v_cvt_pk_bf16_f32 v128, v216, v217
    v_cvt_pk_bf16_f32 v129, v218, v219
    v_cvt_pk_bf16_f32 v130, v220, v221
    v_cvt_pk_bf16_f32 v131, v222, v223
    v_cvt_pk_bf16_f32 v132, v224, v225
    v_cvt_pk_bf16_f32 v133, v226, v227
    v_cvt_pk_bf16_f32 v134, v228, v229
    v_cvt_pk_bf16_f32 v135, v230, v231
    s_mov_b64 exec, -1
    v_mfma_f32_32x32x16_bf16 v[184:199], v[108:111], v[100:103], v[184:199]
    v_max3_f32 v11, v136, v137, v138
    v_max3_f32 v11, v11, v139, v140
    v_max3_f32 v11, v11, v141, v142
    v_max3_f32 v11, v11, v143, v144
    v_max3_f32 v11, v11, v145, v146
    v_max3_f32 v11, v11, v147, v148
    v_max3_f32 v11, v11, v149, v150
    s_nop 4
    v_max3_f32 v13, v184, v185, v186
    v_max3_f32 v13, v13, v187, v188
    v_max3_f32 v13, v13, v189, v190
    v_max3_f32 v13, v13, v191, v192
    v_max3_f32 v13, v13, v193, v194
    s_waitcnt lgkmcnt(4)
    v_mfma_f32_32x32x16_bf16 v[152:167], v[112:115], v[88:91], v[152:167]
    v_max3_f32 v13, v13, v195, v196
    v_max3_f32 v13, v13, v197, v198
    s_waitcnt lgkmcnt(0)
    v_mfma_f32_32x32x16_bf16 v[200:215], v[112:115], v[96:99], v[200:215]
    v_mfma_f32_32x32x16_bf16 v[152:167], v[116:119], v[92:95], v[152:167]
    v_mfma_f32_32x32x16_bf16 v[200:215], v[116:119], v[100:103], v[200:215]
    s_nop 3
    v_max3_f32 v11, v11, v151, v152
    v_max3_f32 v11, v11, v153, v154
    v_max3_f32 v11, v11, v155, v156
    v_max3_f32 v11, v11, v157, v158
    v_max3_f32 v11, v11, v159, v160
    v_max3_f32 v11, v11, v161, v162
    v_max3_f32 v11, v11, v163, v164
    v_max3_f32 v11, v11, v165, v166
    v_max3_f32 v13, v13, v199, v200
    v_max3_f32 v13, v13, v201, v202
    v_max3_f32 v13, v13, v203, v204
    v_max3_f32 v13, v13, v205, v206
    v_max3_f32 v13, v13, v207, v208
    v_max3_f32 v13, v13, v209, v210
    v_max3_f32 v13, v13, v211, v212
    v_max3_f32 v13, v13, v213, v214
    v_max_f32 v11, v11, v167
    v_max_f32 v13, v13, v215
    v_mov_b32 v12, v11
    v_mov_b32 v14, v13
    s_nop 0
    v_permlane32_swap_b32 v11, v12
    v_permlane32_swap_b32 v13, v14
    v_max_f32 v11, v11, v12
    v_max_f32 v13, v13, v14
    v_sub_f32 v136, v136, v11
    v_sub_f32 v137, v137, v11
    v_sub_f32 v184, v184, v13
    v_sub_f32 v185, v185, v13
    v_sub_f32 v138, v138, v11
    v_sub_f32 v139, v139, v11
    v_sub_f32 v186, v186, v13
    v_sub_f32 v187, v187, v13
    v_exp_f32 v136, v136
    v_exp_f32 v137, v137
    v_exp_f32 v184, v184
    v_exp_f32 v185, v185
    v_sub_f32 v140, v140, v11
    v_sub_f32 v141, v141, v11
    v_sub_f32 v142, v142, v11
    v_sub_f32 v143, v143, v11
    v_sub_f32 v188, v188, v13
    v_sub_f32 v189, v189, v13
    v_sub_f32 v190, v190, v13
    v_sub_f32 v191, v191, v13
    v_exp_f32 v138, v138
    v_exp_f32 v139, v139
    v_exp_f32 v186, v186
    v_exp_f32 v187, v187
    v_exp_f32 v140, v140
    v_exp_f32 v141, v141
    v_exp_f32 v142, v142
    v_exp_f32 v143, v143
    v_exp_f32 v188, v188
    v_exp_f32 v189, v189
    v_exp_f32 v190, v190
    v_exp_f32 v191, v191
    v_cvt_pk_bf16_f32 v136, v136, v137
    v_cvt_pk_bf16_f32 v184, v184, v185
    v_cvt_pk_bf16_f32 v137, v138, v139
    v_cvt_pk_bf16_f32 v185, v186, v187
    v_cvt_pk_bf16_f32 v138, v140, v141
    v_cvt_pk_bf16_f32 v139, v142, v143
    v_cvt_pk_bf16_f32 v186, v188, v189
    v_cvt_pk_bf16_f32 v187, v190, v191
    v_mfma_f32_32x32x16_bf16 v[168:183], v[120:123], v[136:139], 0
    v_sub_f32 v144, v144, v11
    v_sub_f32 v145, v145, v11
    v_sub_f32 v146, v146, v11
    v_sub_f32 v147, v147, v11
    v_sub_f32 v148, v148, v11
    v_sub_f32 v149, v149, v11
    v_mfma_f32_32x32x16_bf16 v[216:231], v[120:123], v[184:187], 0
    v_sub_f32 v150, v150, v11
    v_sub_f32 v151, v151, v11
    v_sub_f32 v192, v192, v13
    v_sub_f32 v193, v193, v13
    v_sub_f32 v194, v194, v13
    v_sub_f32 v195, v195, v13
    v_sub_f32 v196, v196, v13
    v_sub_f32 v197, v197, v13
    v_sub_f32 v198, v198, v13
    v_sub_f32 v199, v199, v13
    v_exp_f32 v144, v144
    v_exp_f32 v145, v145
    v_exp_f32 v146, v146
    v_exp_f32 v147, v147
    v_exp_f32 v148, v148
    v_exp_f32 v149, v149
    v_exp_f32 v150, v150
    v_exp_f32 v151, v151
    v_exp_f32 v192, v192
    v_exp_f32 v193, v193
    v_exp_f32 v194, v194
    v_exp_f32 v195, v195
    v_exp_f32 v196, v196
    v_exp_f32 v197, v197
    v_exp_f32 v198, v198
    v_exp_f32 v199, v199
    v_sub_f32 v152, v152, v11
    v_sub_f32 v153, v153, v11
    v_sub_f32 v200, v200, v13
    v_sub_f32 v201, v201, v13
    v_cvt_pk_bf16_f32 v140, v144, v145
    v_cvt_pk_bf16_f32 v141, v146, v147
    v_cvt_pk_bf16_f32 v142, v148, v149
    v_cvt_pk_bf16_f32 v143, v150, v151
    v_cvt_pk_bf16_f32 v188, v192, v193
    v_cvt_pk_bf16_f32 v189, v194, v195
    v_mfma_f32_32x32x16_bf16 v[168:183], v[124:127], v[140:143], v[168:183]
    v_cvt_pk_bf16_f32 v190, v196, v197
    v_cvt_pk_bf16_f32 v191, v198, v199
    v_sub_f32 v154, v154, v11
    v_sub_f32 v155, v155, v11
    v_sub_f32 v202, v202, v13
    v_sub_f32 v203, v203, v13
    v_mfma_f32_32x32x16_bf16 v[216:231], v[124:127], v[188:191], v[216:231]
    v_exp_f32 v152, v152
    v_exp_f32 v153, v153
    v_exp_f32 v200, v200
    v_exp_f32 v201, v201
    v_sub_f32 v156, v156, v11
    v_sub_f32 v157, v157, v11
    v_sub_f32 v158, v158, v11
    v_sub_f32 v159, v159, v11
    v_sub_f32 v204, v204, v13
    v_sub_f32 v205, v205, v13
    v_sub_f32 v206, v206, v13
    v_sub_f32 v207, v207, v13
    v_exp_f32 v154, v154
    v_exp_f32 v155, v155
    v_exp_f32 v202, v202
    v_exp_f32 v203, v203
    v_exp_f32 v156, v156
    v_exp_f32 v157, v157
    v_exp_f32 v158, v158
    v_exp_f32 v159, v159
    v_exp_f32 v204, v204
    v_exp_f32 v205, v205
    v_exp_f32 v206, v206
    v_exp_f32 v207, v207
    v_cvt_pk_bf16_f32 v152, v152, v153
    v_cvt_pk_bf16_f32 v200, v200, v201
    v_cvt_pk_bf16_f32 v153, v154, v155
    v_cvt_pk_bf16_f32 v201, v202, v203
    v_cvt_pk_bf16_f32 v154, v156, v157
    v_cvt_pk_bf16_f32 v155, v158, v159
    v_cvt_pk_bf16_f32 v202, v204, v205
    v_cvt_pk_bf16_f32 v203, v206, v207
    v_mfma_f32_32x32x16_bf16 v[168:183], v[128:131], v[152:155], v[168:183]
    v_sub_f32 v160, v160, v11
    v_sub_f32 v161, v161, v11
    v_sub_f32 v162, v162, v11
    v_sub_f32 v163, v163, v11
    v_sub_f32 v164, v164, v11
    v_sub_f32 v165, v165, v11
    v_mfma_f32_32x32x16_bf16 v[216:231], v[128:131], v[200:203], v[216:231]
    v_sub_f32 v166, v166, v11
    v_sub_f32 v167, v167, v11
    v_sub_f32 v208, v208, v13
    v_sub_f32 v209, v209, v13
    v_sub_f32 v210, v210, v13
    v_sub_f32 v211, v211, v13
    v_sub_f32 v212, v212, v13
    v_sub_f32 v213, v213, v13
    v_sub_f32 v214, v214, v13
    v_sub_f32 v215, v215, v13
    v_exp_f32 v160, v160
    v_exp_f32 v161, v161
    v_exp_f32 v162, v162
    v_exp_f32 v163, v163
    v_exp_f32 v164, v164
    v_exp_f32 v165, v165
    v_exp_f32 v166, v166
    v_exp_f32 v167, v167
    v_exp_f32 v208, v208
    v_exp_f32 v209, v209
    v_exp_f32 v210, v210
    v_exp_f32 v211, v211
    v_exp_f32 v212, v212
    v_exp_f32 v213, v213
    v_exp_f32 v214, v214
    v_exp_f32 v215, v215
    v_cvt_pk_bf16_f32 v156, v160, v161
    v_cvt_pk_bf16_f32 v157, v162, v163
    v_cvt_pk_bf16_f32 v158, v164, v165
    v_cvt_pk_bf16_f32 v159, v166, v167
    v_cvt_pk_bf16_f32 v204, v208, v209
    v_cvt_pk_bf16_f32 v205, v210, v211
    v_mfma_f32_32x32x16_bf16 v[168:183], v[132:135], v[156:159], v[168:183]
    v_cvt_pk_bf16_f32 v206, v212, v213
    v_cvt_pk_bf16_f32 v207, v214, v215
    ds_read_b32 v13, v1
    s_nop 0
    v_mfma_f32_32x32x16_bf16 v[216:231], v[132:135], v[204:207], v[216:231]
    s_nop 3
    v_rcp_f32 v11, v180
    s_nop 0
    v_mul_f32 v168, v168, v11
    v_mul_f32 v169, v169, v11
    v_cvt_pk_bf16_f32 v168, v168, v169
    v_mul_f32 v170, v170, v11
    v_mul_f32 v171, v171, v11
    s_nop 0
    v_rcp_f32 v12, v228
    v_cvt_pk_bf16_f32 v169, v170, v171
    v_mul_f32 v216, v216, v12
    v_mul_f32 v217, v217, v12
    v_cvt_pk_bf16_f32 v216, v216, v217
    v_mul_f32 v218, v218, v12
    v_mul_f32 v219, v219, v12
    v_mul_f32 v172, v172, v11
    v_mul_f32 v173, v173, v11
    v_cvt_pk_bf16_f32 v217, v218, v219
    v_mul_f32 v220, v220, v12
    v_mul_f32 v221, v221, v12
    v_cvt_pk_bf16_f32 v170, v172, v173
    v_mul_f32 v174, v174, v11
    v_mul_f32 v175, v175, v11
    v_mul_f32 v176, v176, v11
    v_mul_f32 v177, v177, v11
    v_mul_f32 v178, v178, v11
    v_mul_f32 v179, v179, v11
    v_cvt_pk_bf16_f32 v218, v220, v221
    v_mul_f32 v222, v222, v12
    v_mul_f32 v223, v223, v12
    v_mul_f32 v224, v224, v12
    v_mul_f32 v225, v225, v12
    v_mul_f32 v226, v226, v12
    v_mul_f32 v227, v227, v12
    v_cvt_pk_bf16_f32 v171, v174, v175
    v_cvt_pk_bf16_f32 v172, v176, v177
    v_cvt_pk_bf16_f32 v173, v178, v179
    v_cvt_pk_bf16_f32 v219, v222, v223
    v_cvt_pk_bf16_f32 v220, v224, v225
    v_cvt_pk_bf16_f32 v221, v226, v227
    s_waitcnt lgkmcnt(0)
    s_nop 3
    s_branch L_slow_RA_ret
L_slow_RB:
    ds_read_b128 v[168:171], v6 offset:0
    ds_read_b64_tr_b16 v[184:185], v7 offset:0
    ds_read_b64_tr_b16 v[186:187], v7 offset:1536
    ds_read_b64_tr_b16 v[188:189], v7 offset:8
    ds_read_b64_tr_b16 v[190:191], v7 offset:1544
    ds_read_b64_tr_b16 v[192:193], v7 offset:64
    ds_read_b64_tr_b16 v[194:195], v7 offset:1600
    ds_read_b64_tr_b16 v[196:197], v7 offset:72
    ds_read_b64_tr_b16 v[198:199], v7 offset:1608
    ds_read_b64_tr_b16 v[180:181], v7 offset:128
    ds_read_b64_tr_b16 v[182:183], v7 offset:1664
    ds_read_b128 v[172:175], v6 offset:16
    ds_read_b128 v[176:179], v6 offset:32
    ds_read_b128 v[232:235], v2 offset:0
    ds_read_b128 v[236:239], v3 offset:0
    s_waitcnt lgkmcnt(12)
    v_mfma_f32_16x16x32_bf16 v[216:219], v[184:187], v[168:171], 0
    ds_read_b64_tr_b16 v[184:185], v7 offset:136
    ds_read_b64_tr_b16 v[186:187], v7 offset:1672
    s_waitcnt lgkmcnt(12)
    v_mfma_f32_16x16x32_bf16 v[220:223], v[188:191], v[168:171], 0
    ds_read_b64_tr_b16 v[188:189], v7 offset:768
    ds_read_b64_tr_b16 v[190:191], v7 offset:2304
    s_waitcnt lgkmcnt(12)
    v_mfma_f32_16x16x32_bf16 v[224:227], v[192:195], v[168:171], 0
    ds_read_b64_tr_b16 v[192:193], v7 offset:776
    ds_read_b64_tr_b16 v[194:195], v7 offset:2312
    s_waitcnt lgkmcnt(12)
    v_mfma_f32_16x16x32_bf16 v[228:231], v[196:199], v[168:171], 0
    ds_read_b64_tr_b16 v[196:197], v7 offset:832
    ds_read_b64_tr_b16 v[198:199], v7 offset:2368
    s_waitcnt lgkmcnt(12)
    v_mfma_f32_16x16x32_bf16 v[200:203], v[180:183], v[168:171], 0
    ds_read_b64_tr_b16 v[180:181], v7 offset:840
    ds_read_b64_tr_b16 v[182:183], v7 offset:2376
    s_waitcnt lgkmcnt(11)
    v_mfma_f32_32x32x16_bf16 v[136:151], v[16:19], v[232:235], 0
    ds_read_b128 v[240:243], v2 offset:64
    ds_read_b128 v[244:247], v3 offset:64
    ds_read_b128 v[248:251], v2 offset:128
    v_mfma_f32_32x32x16_bf16 v[152:167], v[40:43], v[232:235], 0
    ds_read_b128 v[252:255], v3 offset:128
    s_waitcnt lgkmcnt(14)
    v_mfma_f32_32x32x16_bf16 v[136:151], v[20:23], v[236:239], v[136:151]
    s_waitcnt lgkmcnt(12)
    v_mfma_f32_16x16x32_bf16 v[204:207], v[184:187], v[168:171], 0
    ds_read_b64_tr_b16 v[184:185], v7 offset:896
    ds_read_b64_tr_b16 v[186:187], v7 offset:2432
    s_waitcnt lgkmcnt(12)
    v_mfma_f32_16x16x32_bf16 v[216:219], v[188:191], v[172:175], v[216:219]
    ds_read_b64_tr_b16 v[188:189], v7 offset:904
    ds_read_b64_tr_b16 v[190:191], v7 offset:2440
    s_waitcnt lgkmcnt(12)
    v_mfma_f32_16x16x32_bf16 v[220:223], v[192:195], v[172:175], v[220:223]
    ds_read_b64_tr_b16 v[192:193], v7 offset:3072
    ds_read_b64_tr_b16 v[194:195], v7 offset:3840
    s_waitcnt lgkmcnt(12)
    v_mfma_f32_16x16x32_bf16 v[224:227], v[196:199], v[172:175], v[224:227]
    ds_read_b64_tr_b16 v[196:197], v7 offset:3080
    ds_read_b64_tr_b16 v[198:199], v7 offset:3848
    s_waitcnt lgkmcnt(12)
    v_mfma_f32_16x16x32_bf16 v[228:231], v[180:183], v[172:175], v[228:231]
    ds_read_b64_tr_b16 v[180:181], v7 offset:3136
    ds_read_b64_tr_b16 v[182:183], v7 offset:3904
    v_mfma_f32_32x32x16_bf16 v[152:167], v[44:47], v[236:239], v[152:167]
    s_waitcnt lgkmcnt(13)
    v_mfma_f32_32x32x16_bf16 v[136:151], v[24:27], v[240:243], v[136:151]
    v_mfma_f32_32x32x16_bf16 v[152:167], v[48:51], v[240:243], v[152:167]
    s_waitcnt lgkmcnt(8)
    v_mfma_f32_16x16x32_bf16 v[200:203], v[184:187], v[172:175], v[200:203]
    ds_read_b64_tr_b16 v[184:185], v7 offset:3144
    ds_read_b64_tr_b16 v[186:187], v7 offset:3912
    s_waitcnt lgkmcnt(8)
    v_mfma_f32_16x16x32_bf16 v[204:207], v[188:191], v[172:175], v[204:207]
    ds_read_b64_tr_b16 v[188:189], v7 offset:3200
    ds_read_b64_tr_b16 v[190:191], v7 offset:3968
    s_waitcnt lgkmcnt(8)
    v_mfma_f32_16x16x32_bf16 v[216:219], v[192:195], v[176:179], v[216:219]
    ds_read_b64_tr_b16 v[192:193], v7 offset:3208
    ds_read_b64_tr_b16 v[194:195], v7 offset:3976
    s_waitcnt lgkmcnt(8)
    v_mfma_f32_16x16x32_bf16 v[220:223], v[196:199], v[176:179], v[220:223]
    s_waitcnt lgkmcnt(6)
    v_mfma_f32_16x16x32_bf16 v[224:227], v[180:183], v[176:179], v[224:227]
    v_mul_f32 v14, v216, v216
    v_add_f32 v13, v216, v217
    v_mfma_f32_32x32x16_bf16 v[136:151], v[28:31], v[244:247], v[136:151]
    v_fmac_f32 v14, v217, v217
    v_add_f32 v13, v13, v218
    v_fmac_f32 v14, v218, v218
    v_add_f32 v13, v13, v219
    v_fmac_f32 v14, v219, v219
    v_add_f32 v13, v13, v220
    v_mfma_f32_32x32x16_bf16 v[152:167], v[52:55], v[244:247], v[152:167]
    v_fmac_f32 v14, v220, v220
    v_add_f32 v13, v13, v221
    v_fmac_f32 v14, v221, v221
    v_add_f32 v13, v13, v222
    v_fmac_f32 v14, v222, v222
    v_add_f32 v13, v13, v223
    v_mfma_f32_32x32x16_bf16 v[136:151], v[32:35], v[248:251], v[136:151]
    v_fmac_f32 v14, v223, v223
    v_add_f32 v13, v13, v224
    v_fmac_f32 v14, v224, v224
    v_add_f32 v13, v13, v225
    v_fmac_f32 v14, v225, v225
    v_add_f32 v13, v13, v226
    s_waitcnt lgkmcnt(4)
    v_mfma_f32_16x16x32_bf16 v[228:231], v[184:187], v[176:179], v[228:231]
    v_fmac_f32 v14, v226, v226
    v_add_f32 v13, v13, v227
    s_waitcnt lgkmcnt(2)
    v_mfma_f32_16x16x32_bf16 v[200:203], v[188:191], v[176:179], v[200:203]
    v_fmac_f32 v14, v227, v227
    s_waitcnt lgkmcnt(0)
    v_mfma_f32_16x16x32_bf16 v[204:207], v[192:195], v[176:179], v[204:207]
    v_add_f32 v13, v13, v228
    v_fmac_f32 v14, v228, v228
    v_mfma_f32_32x32x16_bf16 v[168:183], v[232:235], v[64:67], 0
    v_add_f32 v13, v13, v229
    v_fmac_f32 v14, v229, v229
    v_add_f32 v13, v13, v230
    v_fmac_f32 v14, v230, v230
    v_add_f32 v13, v13, v231
    v_fmac_f32 v14, v231, v231
    v_mfma_f32_32x32x16_bf16 v[168:183], v[236:239], v[68:71], v[168:183]
    v_add_f32 v13, v13, v200
    v_fmac_f32 v14, v200, v200
    v_add_f32 v13, v13, v201
    v_fmac_f32 v14, v201, v201
    v_add_f32 v13, v13, v202
    v_fmac_f32 v14, v202, v202
    v_mfma_f32_32x32x16_bf16 v[168:183], v[240:243], v[72:75], v[168:183]
    v_add_f32 v13, v13, v203
    v_fmac_f32 v14, v203, v203
    v_add_f32 v13, v13, v204
    v_fmac_f32 v14, v204, v204
    v_add_f32 v13, v13, v205
    v_fmac_f32 v14, v205, v205
    v_mfma_f32_32x32x16_bf16 v[168:183], v[244:247], v[76:79], v[168:183]
    v_add_f32 v13, v13, v206
    v_fmac_f32 v14, v206, v206
    v_add_f32 v13, v13, v207
    v_fmac_f32 v14, v207, v207
    ds_read_b128 v[232:235], v2 offset:6144
    ds_read_b128 v[236:239], v3 offset:6144
    v_mfma_f32_32x32x16_bf16 v[152:167], v[56:59], v[248:251], v[152:167]
    v_permlane32_swap_b32 v13, v14
    v_add_f32 v13, v13, v14
    v_mov_b32 v14, v13
    ds_read_b128 v[240:243], v2 offset:6208
    ds_read_b128 v[244:247], v3 offset:6208
    v_mfma_f32_32x32x16_bf16 v[168:183], v[248:251], v[80:83], v[168:183]
    v_permlane16_swap_b32 v13, v14
    v_add_f32 v13, v13, v14
    v_mov_b32 v14, v13
    ds_read_b128 v[248:251], v2 offset:6272
    v_mfma_f32_32x32x16_bf16 v[136:151], v[36:39], v[252:255], v[136:151]
    v_permlane32_swap_b32 v13, v14
    v_mul_f32 v13, s82, v13
    v_fma_f32 v1, -v13, v13, s83
    v_fma_f32 v14, v14, s82, v1
    v_rsq_f32 v14, v14
    v_mfma_f32_32x32x16_bf16 v[152:167], v[60:63], v[252:255], v[152:167]
    v_mul_f32 v13, -v13, v14
    v_fma_f32 v200, v200, v14, v13
    v_fma_f32 v201, v201, v14, v13
    v_fma_f32 v202, v202, v14, v13
    v_fma_f32 v203, v203, v14, v13
    v_cvt_pk_bf16_f32 v200, v200, v201
    s_waitcnt lgkmcnt(4)
    v_mfma_f32_32x32x16_bf16 v[184:199], v[16:19], v[232:235], 0
    v_fma_f32 v204, v204, v14, v13
    v_fma_f32 v205, v205, v14, v13
    v_fma_f32 v206, v206, v14, v13
    v_fma_f32 v207, v207, v14, v13
    v_cvt_pk_bf16_f32 v201, v202, v203
    v_cvt_pk_bf16_f32 v202, v204, v205
    v_mfma_f32_32x32x16_bf16 v[168:183], v[252:255], v[84:87], v[168:183]
    v_cvt_pk_bf16_f32 v203, v206, v207
    buffer_store_dwordx4 v[200:203], v8, s[20:23], 0 offen offset:128 sc1 nt
    ds_read_b128 v[252:255], v3 offset:6272
    v_fma_f32 v216, v216, v14, v13
    v_fma_f32 v217, v217, v14, v13
    v_fma_f32 v218, v218, v14, v13
    v_mfma_f32_32x32x16_bf16 v[200:215], v[40:43], v[232:235], 0
    v_fma_f32 v219, v219, v14, v13
    v_fma_f32 v220, v220, v14, v13
    v_fma_f32 v221, v221, v14, v13
    v_fma_f32 v222, v222, v14, v13
    v_fma_f32 v223, v223, v14, v13
    v_fma_f32 v224, v224, v14, v13
    s_waitcnt lgkmcnt(4)
    v_mfma_f32_32x32x16_bf16 v[184:199], v[20:23], v[236:239], v[184:199]
    v_fma_f32 v225, v225, v14, v13
    v_fma_f32 v226, v226, v14, v13
    v_fma_f32 v227, v227, v14, v13
    v_fma_f32 v228, v228, v14, v13
    v_fma_f32 v229, v229, v14, v13
    v_fma_f32 v230, v230, v14, v13
    v_mfma_f32_32x32x16_bf16 v[200:215], v[44:47], v[236:239], v[200:215]
    v_fma_f32 v231, v231, v14, v13
    v_fmaak_f32 v11, v136, v136, 0x2b0cbccc
    v_fmaak_f32 v12, v152, v152, 0x2b0cbccc
    v_fmac_f32 v11, v137, v137
    v_fmac_f32 v12, v153, v153
    v_fmac_f32 v11, v138, v138
    s_waitcnt lgkmcnt(3)
    v_mfma_f32_32x32x16_bf16 v[184:199], v[24:27], v[240:243], v[184:199]
    v_fmac_f32 v12, v154, v154
    v_fmac_f32 v11, v139, v139
    v_fmac_f32 v12, v155, v155
    v_fmac_f32 v11, v140, v140
    v_fmac_f32 v12, v156, v156
    v_fmac_f32 v11, v141, v141
    v_mfma_f32_32x32x16_bf16 v[200:215], v[48:51], v[240:243], v[200:215]
    v_fmac_f32 v12, v157, v157
    v_fmac_f32 v11, v142, v142
    v_fmac_f32 v12, v158, v158
    v_fmac_f32 v11, v143, v143
    v_fmac_f32 v12, v159, v159
    v_fmac_f32 v11, v144, v144
    s_waitcnt lgkmcnt(2)
    v_mfma_f32_32x32x16_bf16 v[184:199], v[28:31], v[244:247], v[184:199]
    v_fmac_f32 v12, v160, v160
    v_fmac_f32 v11, v145, v145
    v_fmac_f32 v12, v161, v161
    v_fmac_f32 v11, v146, v146
    v_fmac_f32 v12, v162, v162
    v_fmac_f32 v11, v147, v147
    v_mfma_f32_32x32x16_bf16 v[200:215], v[52:55], v[244:247], v[200:215]
    v_fmac_f32 v12, v163, v163
    ds_read_b128 v[148:151], v0 offset:256
    ds_read_b128 v[164:167], v0 offset:0
    v_permlane32_swap_b32 v11, v12
    v_add_f32 v11, v11, v12
    s_waitcnt lgkmcnt(3)
    v_mfma_f32_32x32x16_bf16 v[184:199], v[32:35], v[248:251], v[184:199]
    v_rsq_f32 v11, v11
    v_cvt_pk_bf16_f32 v216, v216, v217
    v_mul_f32 v11, v11, v10
    v_mov_b32 v12, v11
    v_cvt_pk_bf16_f32 v224, v224, v225
    v_mfma_f32_32x32x16_bf16 v[200:215], v[56:59], v[248:251], v[200:215]
    v_permlane32_swap_b32 v11, v12
    v_mul_f32 v136, v136, v11
    v_mul_f32 v137, v137, v11
    v_mul_f32 v138, v138, v11
    v_mul_f32 v139, v139, v11
    s_waitcnt lgkmcnt(2)
    v_mfma_f32_32x32x16_bf16 v[184:199], v[36:39], v[252:255], v[184:199]
    v_mul_f32 v140, v140, v11
    v_mul_f32 v141, v141, v11
    v_mul_f32 v142, v142, v11
    v_mul_f32 v143, v143, v11
    v_mul_f32 v144, v144, v11
    v_mul_f32 v145, v145, v11
    v_mfma_f32_32x32x16_bf16 v[200:215], v[60:63], v[252:255], v[200:215]
    v_mul_f32 v146, v146, v11
    v_mul_f32 v147, v147, v11
    v_cvt_pk_bf16_f32 v88, v136, v137
    s_nop 0
    v_fmaak_f32 v13, v184, v184, 0x2b0cbccc
    v_fmac_f32 v13, v185, v185
    v_fmac_f32 v13, v186, v186
    v_fmac_f32 v13, v187, v187
    v_fmac_f32 v13, v188, v188
    v_fmac_f32 v13, v189, v189
    v_fmac_f32 v13, v190, v190
    v_fmac_f32 v13, v191, v191
    v_fmaak_f32 v14, v200, v200, 0x2b0cbccc
    v_fmac_f32 v14, v201, v201
    v_fmac_f32 v14, v202, v202
    v_fmac_f32 v14, v203, v203
    v_fmac_f32 v14, v204, v204
    v_fmac_f32 v14, v205, v205
    v_fmac_f32 v14, v206, v206
    v_fmac_f32 v14, v207, v207
    v_fmac_f32 v13, v192, v192
    v_fmac_f32 v14, v208, v208
    v_fmac_f32 v13, v193, v193
    v_fmac_f32 v14, v209, v209
    v_fmac_f32 v13, v194, v194
    v_fmac_f32 v14, v210, v210
    v_fmac_f32 v13, v195, v195
    v_fmac_f32 v14, v211, v211
    v_cvt_pk_bf16_f32 v89, v138, v139
    v_cvt_pk_bf16_f32 v90, v140, v141
    v_permlane32_swap_b32 v13, v14
    v_add_f32 v13, v13, v14
    v_rsq_f32 v13, v13
    v_cvt_pk_bf16_f32 v91, v142, v143
    v_mul_f32 v13, v13, v10
    v_mov_b32 v14, v13
    v_cvt_pk_bf16_f32 v92, v144, v145
    v_cvt_pk_bf16_f32 v93, v146, v147
    v_permlane32_swap_b32 v13, v14
    v_mul_f32 v184, v184, v13
    v_mul_f32 v185, v185, v13
    v_mul_f32 v186, v186, v13
    v_mul_f32 v187, v187, v13
    v_mul_f32 v188, v188, v13
    v_mul_f32 v189, v189, v13
    v_mul_f32 v190, v190, v13
    v_mul_f32 v191, v191, v13
    v_mul_f32 v192, v192, v13
    v_mul_f32 v193, v193, v13
    v_mul_f32 v194, v194, v13
    v_mul_f32 v195, v195, v13
    v_cvt_pk_bf16_f32 v96, v184, v185
    v_cvt_pk_bf16_f32 v97, v186, v187
    v_cvt_pk_bf16_f32 v98, v188, v189
    v_cvt_pk_bf16_f32 v99, v190, v191
    v_cvt_pk_bf16_f32 v100, v192, v193
    v_cvt_pk_bf16_f32 v101, v194, v195
    ds_read_b128 v[136:139], v0 offset:448
    ds_read_b128 v[140:143], v0 offset:384
    ds_read_b128 v[144:147], v0 offset:320
    ds_read_b128 v[184:187], v0 offset:704
    ds_read_b128 v[188:191], v0 offset:640
    ds_read_b128 v[192:195], v0 offset:576
    ds_read_b128 v[196:199], v0 offset:512
    v_mul_f32 v152, v152, v12
    v_mul_f32 v153, v153, v12
    v_mul_f32 v154, v154, v12
    v_mul_f32 v155, v155, v12
    v_mul_f32 v156, v156, v12
    v_mul_f32 v157, v157, v12
    v_mul_f32 v158, v158, v12
    v_mul_f32 v159, v159, v12
    v_mul_f32 v160, v160, v12
    v_mul_f32 v161, v161, v12
    v_mul_f32 v162, v162, v12
    v_mul_f32 v163, v163, v12
    v_mul_f32 v200, v200, v14
    v_mul_f32 v201, v201, v14
    v_mul_f32 v202, v202, v14
    v_mul_f32 v203, v203, v14
    v_mul_f32 v204, v204, v14
    v_mul_f32 v205, v205, v14
    v_mul_f32 v206, v206, v14
    v_mul_f32 v207, v207, v14
    v_mul_f32 v208, v208, v14
    v_mul_f32 v209, v209, v14
    v_mul_f32 v210, v210, v14
    v_mul_f32 v211, v211, v14
    v_cvt_pk_bf16_f32 v104, v152, v153
    v_cvt_pk_bf16_f32 v105, v154, v155
    v_cvt_pk_bf16_f32 v106, v156, v157
    v_cvt_pk_bf16_f32 v107, v158, v159
    v_cvt_pk_bf16_f32 v108, v160, v161
    v_cvt_pk_bf16_f32 v109, v162, v163
    s_waitcnt lgkmcnt(4)
    v_mfma_f32_32x32x16_bf16 v[136:151], v[104:107], v[88:91], v[136:151]
    v_cvt_pk_bf16_f32 v112, v200, v201
    v_cvt_pk_bf16_f32 v113, v202, v203
    v_cvt_pk_bf16_f32 v114, v204, v205
    v_cvt_pk_bf16_f32 v115, v206, v207
    v_cvt_pk_bf16_f32 v116, v208, v209
    v_cvt_pk_bf16_f32 v117, v210, v211
    s_waitcnt lgkmcnt(0)
    v_mfma_f32_32x32x16_bf16 v[184:199], v[104:107], v[96:99], v[184:199]
    ds_read_b128 v[152:155], v0 offset:192
    ds_read_b128 v[156:159], v0 offset:128
    ds_read_b128 v[160:163], v0 offset:64
    ds_read_b128 v[200:203], v0 offset:448
    ds_read_b128 v[204:207], v0 offset:384
    ds_read_b128 v[208:211], v0 offset:320
    v_mfma_f32_32x32x16_bf16 v[136:151], v[108:111], v[92:95], v[136:151]
    ds_read_b128 v[212:215], v0 offset:256
    v_cvt_pk_bf16_f32 v217, v218, v219
    v_cvt_pk_bf16_f32 v225, v226, v227
    v_cvt_pk_bf16_f32 v218, v220, v221
    v_cvt_pk_bf16_f32 v219, v222, v223
    v_cvt_pk_bf16_f32 v226, v228, v229
    v_mfma_f32_32x32x16_bf16 v[184:199], v[108:111], v[100:103], v[184:199]
    v_cvt_pk_bf16_f32 v227, v230, v231
    buffer_store_dwordx4 v[216:219], v8, s[20:23], 0 offen offset:0 sc1 nt
    buffer_store_dwordx4 v[224:227], v8, s[20:23], 0 offen offset:64 sc1 nt
    s_nop 0
    v_max3_f32 v11, v136, v137, v138
    v_max3_f32 v11, v11, v139, v140
    v_max3_f32 v11, v11, v141, v142
    v_mfma_f32_32x32x16_bf16 v[216:231], v[232:235], v[64:67], 0
    v_max3_f32 v11, v11, v143, v144
    v_max3_f32 v11, v11, v145, v146
    v_max3_f32 v11, v11, v147, v148
    s_nop 0
    v_max3_f32 v13, v184, v185, v186
    v_max3_f32 v13, v13, v187, v188
    v_max3_f32 v13, v13, v189, v190
    v_mfma_f32_32x32x16_bf16 v[216:231], v[236:239], v[68:71], v[216:231]
    v_max3_f32 v13, v13, v191, v192
    v_max3_f32 v13, v13, v193, v194
    v_max3_f32 v13, v13, v195, v196
    v_max3_f32 v11, v11, v149, v150
    v_max3_f32 v13, v13, v197, v198
    s_mov_b64 exec, s[76:77]
    v_cvt_pk_bf16_f32 v120, v168, v169
    v_cvt_pk_bf16_f32 v121, v170, v171
    v_cvt_pk_bf16_f32 v122, v172, v173
    v_cvt_pk_bf16_f32 v123, v174, v175
    v_cvt_pk_bf16_f32 v124, v176, v177
    v_cvt_pk_bf16_f32 v125, v178, v179
    v_cvt_pk_bf16_f32 v126, v180, v181
    v_cvt_pk_bf16_f32 v127, v182, v183
    s_mov_b64 exec, -1
    s_waitcnt lgkmcnt(4)
    v_mfma_f32_32x32x16_bf16 v[152:167], v[112:115], v[88:91], v[152:167]
    s_waitcnt lgkmcnt(0)
    v_mfma_f32_32x32x16_bf16 v[200:215], v[112:115], v[96:99], v[200:215]
    v_mfma_f32_32x32x16_bf16 v[216:231], v[240:243], v[72:75], v[216:231]
    v_mfma_f32_32x32x16_bf16 v[152:167], v[116:119], v[92:95], v[152:167]
    v_mfma_f32_32x32x16_bf16 v[200:215], v[116:119], v[100:103], v[200:215]
    s_nop 3
    v_max3_f32 v11, v11, v151, v152
    v_max3_f32 v11, v11, v153, v154
    v_max3_f32 v11, v11, v155, v156
    v_mfma_f32_32x32x16_bf16 v[216:231], v[244:247], v[76:79], v[216:231]
    v_max3_f32 v11, v11, v157, v158
    v_max3_f32 v11, v11, v159, v160
    v_max3_f32 v11, v11, v161, v162
    s_nop 0
    v_max3_f32 v13, v13, v199, v200
    v_max3_f32 v13, v13, v201, v202
    v_max3_f32 v13, v13, v203, v204
    v_mfma_f32_32x32x16_bf16 v[216:231], v[248:251], v[80:83], v[216:231]
    v_max3_f32 v13, v13, v205, v206
    v_max3_f32 v13, v13, v207, v208
    v_max3_f32 v13, v13, v209, v210
    v_max3_f32 v11, v11, v163, v164
    v_max3_f32 v13, v13, v211, v212
    v_max3_f32 v11, v11, v165, v166
    v_mfma_f32_32x32x16_bf16 v[216:231], v[252:255], v[84:87], v[216:231]
    v_max3_f32 v13, v13, v213, v214
    v_max_f32 v11, v11, v167
    v_max_f32 v13, v13, v215
    v_mov_b32 v12, v11
    v_mov_b32 v14, v13
    s_nop 0
    v_permlane32_swap_b32 v11, v12
    v_permlane32_swap_b32 v13, v14
    v_max_f32 v11, v11, v12
    s_mov_b64 exec, s[76:77]
    s_nop 1
    v_cvt_pk_bf16_f32 v128, v216, v217
    v_cvt_pk_bf16_f32 v129, v218, v219
    v_cvt_pk_bf16_f32 v130, v220, v221
    v_cvt_pk_bf16_f32 v131, v222, v223
    v_cvt_pk_bf16_f32 v132, v224, v225
    v_cvt_pk_bf16_f32 v133, v226, v227
    v_cvt_pk_bf16_f32 v134, v228, v229
    v_cvt_pk_bf16_f32 v135, v230, v231
    s_mov_b64 exec, -1
    v_max_f32 v13, v13, v14
    v_sub_f32 v136, v136, v11
    v_sub_f32 v137, v137, v11
    v_sub_f32 v184, v184, v13
    v_sub_f32 v185, v185, v13
    v_sub_f32 v138, v138, v11
    v_sub_f32 v139, v139, v11
    v_sub_f32 v186, v186, v13
    v_sub_f32 v187, v187, v13
    v_exp_f32 v136, v136
    v_exp_f32 v137, v137
    v_exp_f32 v184, v184
    v_exp_f32 v185, v185
    v_sub_f32 v140, v140, v11
    v_sub_f32 v141, v141, v11
    v_sub_f32 v142, v142, v11
    v_sub_f32 v143, v143, v11
    v_sub_f32 v188, v188, v13
    v_sub_f32 v189, v189, v13
    v_sub_f32 v190, v190, v13
    v_sub_f32 v191, v191, v13
    v_exp_f32 v138, v138
    v_exp_f32 v139, v139
    v_exp_f32 v186, v186
    v_exp_f32 v187, v187
    v_exp_f32 v140, v140
    v_exp_f32 v141, v141
    v_exp_f32 v142, v142
    v_exp_f32 v143, v143
    v_exp_f32 v188, v188
    v_exp_f32 v189, v189
    v_exp_f32 v190, v190
    v_exp_f32 v191, v191
    v_cvt_pk_bf16_f32 v136, v136, v137
    v_cvt_pk_bf16_f32 v184, v184, v185
    v_cvt_pk_bf16_f32 v137, v138, v139
    v_cvt_pk_bf16_f32 v185, v186, v187
    v_cvt_pk_bf16_f32 v138, v140, v141
    v_cvt_pk_bf16_f32 v139, v142, v143
    v_cvt_pk_bf16_f32 v186, v188, v189
    v_cvt_pk_bf16_f32 v187, v190, v191
    v_mfma_f32_32x32x16_bf16 v[168:183], v[120:123], v[136:139], 0
    v_sub_f32 v144, v144, v11
    v_sub_f32 v145, v145, v11
    v_sub_f32 v146, v146, v11
    v_sub_f32 v147, v147, v11
    v_sub_f32 v148, v148, v11
    v_sub_f32 v149, v149, v11
    v_mfma_f32_32x32x16_bf16 v[216:231], v[120:123], v[184:187], 0
    v_sub_f32 v150, v150, v11
    v_sub_f32 v151, v151, v11
    v_sub_f32 v192, v192, v13
    v_sub_f32 v193, v193, v13
    v_sub_f32 v194, v194, v13
    v_sub_f32 v195, v195, v13
    v_sub_f32 v196, v196, v13
    v_sub_f32 v197, v197, v13
    v_sub_f32 v198, v198, v13
    v_sub_f32 v199, v199, v13
    v_exp_f32 v144, v144
    v_exp_f32 v145, v145
    v_exp_f32 v146, v146
    v_exp_f32 v147, v147
    v_exp_f32 v148, v148
    v_exp_f32 v149, v149
    v_exp_f32 v150, v150
    v_exp_f32 v151, v151
    v_exp_f32 v192, v192
    v_exp_f32 v193, v193
    v_exp_f32 v194, v194
    v_exp_f32 v195, v195
    v_exp_f32 v196, v196
    v_exp_f32 v197, v197
    v_exp_f32 v198, v198
    v_exp_f32 v199, v199
    v_sub_f32 v152, v152, v11
    v_sub_f32 v153, v153, v11
    v_sub_f32 v200, v200, v13
    v_sub_f32 v201, v201, v13
    v_cvt_pk_bf16_f32 v140, v144, v145
    v_cvt_pk_bf16_f32 v141, v146, v147
    v_cvt_pk_bf16_f32 v142, v148, v149
    v_cvt_pk_bf16_f32 v143, v150, v151
    v_cvt_pk_bf16_f32 v188, v192, v193
    v_cvt_pk_bf16_f32 v189, v194, v195
    v_mfma_f32_32x32x16_bf16 v[168:183], v[124:127], v[140:143], v[168:183]
    v_cvt_pk_bf16_f32 v190, v196, v197
    v_cvt_pk_bf16_f32 v191, v198, v199
    v_sub_f32 v154, v154, v11
    v_sub_f32 v155, v155, v11
    v_sub_f32 v202, v202, v13
    v_sub_f32 v203, v203, v13
    v_mfma_f32_32x32x16_bf16 v[216:231], v[124:127], v[188:191], v[216:231]
    v_exp_f32 v152, v152
    v_exp_f32 v153, v153
    v_exp_f32 v200, v200
    v_exp_f32 v201, v201
    v_sub_f32 v156, v156, v11
    v_sub_f32 v157, v157, v11
    v_sub_f32 v158, v158, v11
    v_sub_f32 v159, v159, v11
    v_sub_f32 v204, v204, v13
    v_sub_f32 v205, v205, v13
    v_sub_f32 v206, v206, v13
    v_sub_f32 v207, v207, v13
    v_exp_f32 v154, v154
    v_exp_f32 v155, v155
    v_exp_f32 v202, v202
    v_exp_f32 v203, v203
    v_exp_f32 v156, v156
    v_exp_f32 v157, v157
    v_exp_f32 v158, v158
    v_exp_f32 v159, v159
    v_exp_f32 v204, v204
    v_exp_f32 v205, v205
    v_exp_f32 v206, v206
    v_exp_f32 v207, v207
    v_cvt_pk_bf16_f32 v152, v152, v153
    v_cvt_pk_bf16_f32 v200, v200, v201
    v_cvt_pk_bf16_f32 v153, v154, v155
    v_cvt_pk_bf16_f32 v201, v202, v203
    v_cvt_pk_bf16_f32 v154, v156, v157
    v_cvt_pk_bf16_f32 v155, v158, v159
    v_cvt_pk_bf16_f32 v202, v204, v205
    v_cvt_pk_bf16_f32 v203, v206, v207
    v_mfma_f32_32x32x16_bf16 v[168:183], v[128:131], v[152:155], v[168:183]
    v_sub_f32 v160, v160, v11
    v_sub_f32 v161, v161, v11
    v_sub_f32 v162, v162, v11
    v_sub_f32 v163, v163, v11
    v_sub_f32 v164, v164, v11
    v_sub_f32 v165, v165, v11
    v_mfma_f32_32x32x16_bf16 v[216:231], v[128:131], v[200:203], v[216:231]
    v_sub_f32 v166, v166, v11
    v_sub_f32 v167, v167, v11
    v_sub_f32 v208, v208, v13
    v_sub_f32 v209, v209, v13
    v_sub_f32 v210, v210, v13
    v_sub_f32 v211, v211, v13
    v_sub_f32 v212, v212, v13
    v_sub_f32 v213, v213, v13
    v_sub_f32 v214, v214, v13
    v_sub_f32 v215, v215, v13
    v_exp_f32 v160, v160
    v_exp_f32 v161, v161
    v_exp_f32 v162, v162
    v_exp_f32 v163, v163
    v_exp_f32 v164, v164
    v_exp_f32 v165, v165
    v_exp_f32 v166, v166
    v_exp_f32 v167, v167
    v_exp_f32 v208, v208
    v_exp_f32 v209, v209
    v_exp_f32 v210, v210
    v_exp_f32 v211, v211
    v_exp_f32 v212, v212
    v_exp_f32 v213, v213
    v_exp_f32 v214, v214
    v_exp_f32 v215, v215
    v_cvt_pk_bf16_f32 v156, v160, v161
    v_cvt_pk_bf16_f32 v157, v162, v163
    v_cvt_pk_bf16_f32 v158, v164, v165
    v_cvt_pk_bf16_f32 v159, v166, v167
    v_cvt_pk_bf16_f32 v204, v208, v209
    v_cvt_pk_bf16_f32 v205, v210, v211
    v_mfma_f32_32x32x16_bf16 v[168:183], v[132:135], v[156:159], v[168:183]
    v_cvt_pk_bf16_f32 v206, v212, v213
    v_cvt_pk_bf16_f32 v207, v214, v215
    s_nop 1
    v_mfma_f32_32x32x16_bf16 v[216:231], v[132:135], v[204:207], v[216:231]
    s_nop 3
    v_rcp_f32 v11, v180
    s_nop 0
    v_mul_f32 v168, v168, v11
    v_mul_f32 v169, v169, v11
    v_cvt_pk_bf16_f32 v168, v168, v169
    v_mul_f32 v170, v170, v11
    v_mul_f32 v171, v171, v11
    s_nop 0
    v_rcp_f32 v12, v228
    v_cvt_pk_bf16_f32 v169, v170, v171
    v_mul_f32 v216, v216, v12
    v_mul_f32 v217, v217, v12
    v_cvt_pk_bf16_f32 v216, v216, v217
    v_mul_f32 v218, v218, v12
    v_mul_f32 v219, v219, v12
    v_mul_f32 v172, v172, v11
    v_mul_f32 v173, v173, v11
    v_cvt_pk_bf16_f32 v217, v218, v219
    v_mul_f32 v220, v220, v12
    v_mul_f32 v221, v221, v12
    v_cvt_pk_bf16_f32 v170, v172, v173
    v_mul_f32 v174, v174, v11
    v_mul_f32 v175, v175, v11
    v_mul_f32 v176, v176, v11
    v_mul_f32 v177, v177, v11
    v_mul_f32 v178, v178, v11
    v_mul_f32 v179, v179, v11
    v_cvt_pk_bf16_f32 v218, v220, v221
    v_mul_f32 v222, v222, v12
    v_mul_f32 v223, v223, v12
    v_mul_f32 v224, v224, v12
    v_mul_f32 v225, v225, v12
    v_mul_f32 v226, v226, v12
    v_mul_f32 v227, v227, v12
    v_cvt_pk_bf16_f32 v171, v174, v175
    v_cvt_pk_bf16_f32 v172, v176, v177
    v_cvt_pk_bf16_f32 v173, v178, v179
    v_cvt_pk_bf16_f32 v219, v222, v223
    v_cvt_pk_bf16_f32 v220, v224, v225
    v_cvt_pk_bf16_f32 v221, v226, v227
    ds_write_b128 v4, v[168:171] offset:49152
    ds_write_b64 v5, v[172:173] offset:49152
    ds_write_b128 v4, v[216:219] offset:50688
    ds_write_b64 v5, v[220:221] offset:50688
    s_waitcnt lgkmcnt(0)
    s_branch L_slow_RB_ret
L_slow_RH:
    ds_read_b128 v[168:171], v6 offset:0
    ds_read_b64_tr_b16 v[184:185], v7 offset:0
    ds_read_b64_tr_b16 v[186:187], v7 offset:1536
    ds_read_b64_tr_b16 v[188:189], v7 offset:8
    ds_read_b64_tr_b16 v[190:191], v7 offset:1544
    ds_read_b64_tr_b16 v[192:193], v7 offset:64
    ds_read_b64_tr_b16 v[194:195], v7 offset:1600
    ds_read_b64_tr_b16 v[196:197], v7 offset:72
    ds_read_b64_tr_b16 v[198:199], v7 offset:1608
    ds_read_b64_tr_b16 v[180:181], v7 offset:128
    ds_read_b64_tr_b16 v[182:183], v7 offset:1664
    ds_read_b128 v[172:175], v6 offset:16
    ds_read_b128 v[176:179], v6 offset:32
    ds_read_b128 v[232:235], v2 offset:0
    ds_read_b128 v[236:239], v3 offset:0
    s_waitcnt lgkmcnt(12)
    v_mfma_f32_16x16x32_bf16 v[216:219], v[184:187], v[168:171], 0
    ds_read_b64_tr_b16 v[184:185], v7 offset:136
    ds_read_b64_tr_b16 v[186:187], v7 offset:1672
    s_waitcnt lgkmcnt(12)
    v_mfma_f32_16x16x32_bf16 v[220:223], v[188:191], v[168:171], 0
    ds_read_b64_tr_b16 v[188:189], v7 offset:768
    ds_read_b64_tr_b16 v[190:191], v7 offset:2304
    s_waitcnt lgkmcnt(12)
    v_mfma_f32_16x16x32_bf16 v[224:227], v[192:195], v[168:171], 0
    ds_read_b64_tr_b16 v[192:193], v7 offset:776
    ds_read_b64_tr_b16 v[194:195], v7 offset:2312
    s_waitcnt lgkmcnt(12)
    v_mfma_f32_16x16x32_bf16 v[228:231], v[196:199], v[168:171], 0
    ds_read_b64_tr_b16 v[196:197], v7 offset:832
    ds_read_b64_tr_b16 v[198:199], v7 offset:2368
    s_waitcnt lgkmcnt(12)
    v_mfma_f32_16x16x32_bf16 v[200:203], v[180:183], v[168:171], 0
    ds_read_b64_tr_b16 v[180:181], v7 offset:840
    ds_read_b64_tr_b16 v[182:183], v7 offset:2376
    s_waitcnt lgkmcnt(11)
    v_mfma_f32_32x32x16_bf16 v[136:151], v[16:19], v[232:235], 0
    ds_read_b128 v[240:243], v2 offset:64
    ds_read_b128 v[244:247], v3 offset:64
    ds_read_b128 v[248:251], v2 offset:128
    v_mfma_f32_32x32x16_bf16 v[152:167], v[40:43], v[232:235], 0
    ds_read_b128 v[252:255], v3 offset:128
    s_waitcnt lgkmcnt(14)
    v_mfma_f32_32x32x16_bf16 v[136:151], v[20:23], v[236:239], v[136:151]
    s_waitcnt lgkmcnt(12)
    v_mfma_f32_16x16x32_bf16 v[204:207], v[184:187], v[168:171], 0
    ds_read_b64_tr_b16 v[184:185], v7 offset:896
    ds_read_b64_tr_b16 v[186:187], v7 offset:2432
    s_waitcnt lgkmcnt(12)
    v_mfma_f32_16x16x32_bf16 v[216:219], v[188:191], v[172:175], v[216:219]
    ds_read_b64_tr_b16 v[188:189], v7 offset:904
    ds_read_b64_tr_b16 v[190:191], v7 offset:2440
    s_waitcnt lgkmcnt(12)
    v_mfma_f32_16x16x32_bf16 v[220:223], v[192:195], v[172:175], v[220:223]
    ds_read_b64_tr_b16 v[192:193], v7 offset:3072
    ds_read_b64_tr_b16 v[194:195], v7 offset:3840
    s_waitcnt lgkmcnt(12)
    v_mfma_f32_16x16x32_bf16 v[224:227], v[196:199], v[172:175], v[224:227]
    ds_read_b64_tr_b16 v[196:197], v7 offset:3080
    ds_read_b64_tr_b16 v[198:199], v7 offset:3848
    s_waitcnt lgkmcnt(12)
    v_mfma_f32_16x16x32_bf16 v[228:231], v[180:183], v[172:175], v[228:231]
    ds_read_b64_tr_b16 v[180:181], v7 offset:3136
    ds_read_b64_tr_b16 v[182:183], v7 offset:3904
    v_mfma_f32_32x32x16_bf16 v[152:167], v[44:47], v[236:239], v[152:167]
    s_waitcnt lgkmcnt(13)
    v_mfma_f32_32x32x16_bf16 v[136:151], v[24:27], v[240:243], v[136:151]
    v_mfma_f32_32x32x16_bf16 v[152:167], v[48:51], v[240:243], v[152:167]
    s_waitcnt lgkmcnt(8)
    v_mfma_f32_16x16x32_bf16 v[200:203], v[184:187], v[172:175], v[200:203]
    ds_read_b64_tr_b16 v[184:185], v7 offset:3144
    ds_read_b64_tr_b16 v[186:187], v7 offset:3912
    s_waitcnt lgkmcnt(8)
    v_mfma_f32_16x16x32_bf16 v[204:207], v[188:191], v[172:175], v[204:207]
    ds_read_b64_tr_b16 v[188:189], v7 offset:3200
    ds_read_b64_tr_b16 v[190:191], v7 offset:3968
    s_waitcnt lgkmcnt(8)
    v_mfma_f32_16x16x32_bf16 v[216:219], v[192:195], v[176:179], v[216:219]
    ds_read_b64_tr_b16 v[192:193], v7 offset:3208
    ds_read_b64_tr_b16 v[194:195], v7 offset:3976
    s_waitcnt lgkmcnt(8)
    v_mfma_f32_16x16x32_bf16 v[220:223], v[196:199], v[176:179], v[220:223]
    s_waitcnt lgkmcnt(6)
    v_mfma_f32_16x16x32_bf16 v[224:227], v[180:183], v[176:179], v[224:227]
    v_mul_f32 v14, v216, v216
    v_add_f32 v13, v216, v217
    v_mfma_f32_32x32x16_bf16 v[136:151], v[28:31], v[244:247], v[136:151]
    v_fmac_f32 v14, v217, v217
    v_add_f32 v13, v13, v218
    v_fmac_f32 v14, v218, v218
    v_add_f32 v13, v13, v219
    v_fmac_f32 v14, v219, v219
    v_add_f32 v13, v13, v220
    v_mfma_f32_32x32x16_bf16 v[152:167], v[52:55], v[244:247], v[152:167]
    v_fmac_f32 v14, v220, v220
    v_add_f32 v13, v13, v221
    v_fmac_f32 v14, v221, v221
    v_add_f32 v13, v13, v222
    v_fmac_f32 v14, v222, v222
    v_add_f32 v13, v13, v223
    v_mfma_f32_32x32x16_bf16 v[136:151], v[32:35], v[248:251], v[136:151]
    v_fmac_f32 v14, v223, v223
    v_add_f32 v13, v13, v224
    v_fmac_f32 v14, v224, v224
    v_add_f32 v13, v13, v225
    v_fmac_f32 v14, v225, v225
    v_add_f32 v13, v13, v226
    s_waitcnt lgkmcnt(4)
    v_mfma_f32_16x16x32_bf16 v[228:231], v[184:187], v[176:179], v[228:231]
    v_fmac_f32 v14, v226, v226
    v_add_f32 v13, v13, v227
    s_waitcnt lgkmcnt(2)
    v_mfma_f32_16x16x32_bf16 v[200:203], v[188:191], v[176:179], v[200:203]
    v_fmac_f32 v14, v227, v227
    s_waitcnt lgkmcnt(0)
    v_mfma_f32_16x16x32_bf16 v[204:207], v[192:195], v[176:179], v[204:207]
    v_add_f32 v13, v13, v228
    v_fmac_f32 v14, v228, v228
    v_mfma_f32_32x32x16_bf16 v[168:183], v[232:235], v[64:67], 0
    v_add_f32 v13, v13, v229
    v_fmac_f32 v14, v229, v229
    v_add_f32 v13, v13, v230
    v_fmac_f32 v14, v230, v230
    v_add_f32 v13, v13, v231
    v_fmac_f32 v14, v231, v231
    v_mfma_f32_32x32x16_bf16 v[168:183], v[236:239], v[68:71], v[168:183]
    v_add_f32 v13, v13, v200
    v_fmac_f32 v14, v200, v200
    v_add_f32 v13, v13, v201
    v_fmac_f32 v14, v201, v201
    v_add_f32 v13, v13, v202
    v_fmac_f32 v14, v202, v202
    v_mfma_f32_32x32x16_bf16 v[168:183], v[240:243], v[72:75], v[168:183]
    v_add_f32 v13, v13, v203
    v_fmac_f32 v14, v203, v203
    v_add_f32 v13, v13, v204
    v_fmac_f32 v14, v204, v204
    v_add_f32 v13, v13, v205
    v_fmac_f32 v14, v205, v205
    v_mfma_f32_32x32x16_bf16 v[152:167], v[56:59], v[248:251], v[152:167]
    v_add_f32 v13, v13, v206
    v_fmac_f32 v14, v206, v206
    v_add_f32 v13, v13, v207
    v_fmac_f32 v14, v207, v207
    ds_read_b128 v[232:235], v96 offset:0
    ds_read_b128 v[236:239], v97 offset:0
    v_mfma_f32_32x32x16_bf16 v[168:183], v[244:247], v[76:79], v[168:183]
    v_permlane32_swap_b32 v13, v14
    v_add_f32 v13, v13, v14
    v_mov_b32 v14, v13
    ds_read_b128 v[240:243], v96 offset:64
    ds_read_b128 v[244:247], v97 offset:64
    v_mfma_f32_32x32x16_bf16 v[136:151], v[36:39], v[252:255], v[136:151]
    v_permlane16_swap_b32 v13, v14
    v_add_f32 v13, v13, v14
    v_mov_b32 v14, v13
    v_mfma_f32_32x32x16_bf16 v[152:167], v[60:63], v[252:255], v[152:167]
    s_nop 0
    v_permlane32_swap_b32 v13, v14
    v_mul_f32 v13, s82, v13
    v_fma_f32 v1, -v13, v13, s83
    v_fma_f32 v14, v14, s82, v1
    v_rsq_f32 v14, v14
    v_mfma_f32_32x32x16_bf16 v[168:183], v[248:251], v[80:83], v[168:183]
    v_mul_f32 v13, -v13, v14
    v_fma_f32 v200, v200, v14, v13
    v_fma_f32 v201, v201, v14, v13
    v_fma_f32 v202, v202, v14, v13
    v_fma_f32 v203, v203, v14, v13
    v_cvt_pk_bf16_f32 v200, v200, v201
    v_mfma_f32_32x32x16_bf16 v[168:183], v[252:255], v[84:87], v[168:183]
    v_fma_f32 v204, v204, v14, v13
    v_fma_f32 v205, v205, v14, v13
    v_fma_f32 v206, v206, v14, v13
    v_fma_f32 v207, v207, v14, v13
    v_cvt_pk_bf16_f32 v201, v202, v203
    v_cvt_pk_bf16_f32 v202, v204, v205
    v_cvt_pk_bf16_f32 v203, v206, v207
    buffer_store_dwordx4 v[200:203], v8, s[20:23], 0 offen offset:128 sc1 nt
    s_waitcnt lgkmcnt(3)
    s_nop 0
    v_mfma_f32_32x32x16_bf16 v[200:215], v[40:43], v[232:235], 0
    ds_read_b128 v[248:251], v96 offset:128
    v_fmaak_f32 v11, v136, v136, 0x2b0cbccc
    v_fmaak_f32 v12, v152, v152, 0x2b0cbccc
    v_fmac_f32 v11, v137, v137
    v_fmac_f32 v12, v153, v153
    v_fmac_f32 v11, v138, v138
    s_waitcnt lgkmcnt(3)
    v_mfma_f32_32x32x16_bf16 v[200:215], v[44:47], v[236:239], v[200:215]
    v_fmac_f32 v12, v154, v154
    ds_read_b128 v[252:255], v97 offset:128
    v_fmac_f32 v11, v139, v139
    v_fmac_f32 v12, v155, v155
    v_fmac_f32 v11, v140, v140
    v_fmac_f32 v12, v156, v156
    s_waitcnt lgkmcnt(3)
    v_mfma_f32_32x32x16_bf16 v[200:215], v[48:51], v[240:243], v[200:215]
    v_fmac_f32 v11, v141, v141
    v_fmac_f32 v12, v157, v157
    v_fmac_f32 v11, v142, v142
    v_fmac_f32 v12, v158, v158
    v_fmac_f32 v11, v143, v143
    v_fmac_f32 v12, v159, v159
    s_waitcnt lgkmcnt(2)
    v_mfma_f32_32x32x16_bf16 v[200:215], v[52:55], v[244:247], v[200:215]
    v_fmac_f32 v11, v144, v144
    v_fmac_f32 v12, v160, v160
    v_fmac_f32 v11, v145, v145
    v_fmac_f32 v12, v161, v161
    v_fmac_f32 v11, v146, v146
    v_fmac_f32 v12, v162, v162
    v_fmac_f32 v11, v147, v147
    v_fmac_f32 v12, v163, v163
    ds_read_b128 v[148:151], v0 offset:256
    v_fma_f32 v216, v216, v14, v13
    v_permlane32_swap_b32 v11, v12
    s_waitcnt lgkmcnt(2)
    v_mfma_f32_32x32x16_bf16 v[200:215], v[56:59], v[248:251], v[200:215]
    v_add_f32 v11, v11, v12
    v_rsq_f32 v11, v11
    v_fma_f32 v217, v217, v14, v13
    v_mul_f32 v11, v11, v10
    v_mov_b32 v12, v11
    s_waitcnt lgkmcnt(1)
    v_mfma_f32_32x32x16_bf16 v[200:215], v[60:63], v[252:255], v[200:215]
    v_permlane32_swap_b32 v11, v12
    v_mul_f32 v136, v136, v11
    v_mul_f32 v137, v137, v11
    v_mul_f32 v138, v138, v11
    v_mul_f32 v139, v139, v11
    v_mul_f32 v140, v140, v11
    v_mul_f32 v141, v141, v11
    v_mul_f32 v142, v142, v11
    v_mul_f32 v143, v143, v11
    v_mul_f32 v144, v144, v11
    v_mul_f32 v145, v145, v11
    v_mul_f32 v146, v146, v11
    v_mul_f32 v147, v147, v11
    v_cvt_pk_bf16_f32 v88, v136, v137
    v_cvt_pk_bf16_f32 v89, v138, v139
    v_cvt_pk_bf16_f32 v90, v140, v141
    v_cvt_pk_bf16_f32 v91, v142, v143
    v_cvt_pk_bf16_f32 v92, v144, v145
    v_cvt_pk_bf16_f32 v93, v146, v147
    ds_read_b128 v[136:139], v0 offset:448
    ds_read_b128 v[140:143], v0 offset:384
    ds_read_b128 v[144:147], v0 offset:320
    v_fma_f32 v218, v218, v14, v13
    v_fma_f32 v219, v219, v14, v13
    v_fma_f32 v220, v220, v14, v13
    v_fma_f32 v221, v221, v14, v13
    v_fma_f32 v222, v222, v14, v13
    v_fma_f32 v223, v223, v14, v13
    v_fma_f32 v224, v224, v14, v13
    v_fma_f32 v225, v225, v14, v13
    v_fma_f32 v226, v226, v14, v13
    v_fma_f32 v227, v227, v14, v13
    v_fma_f32 v228, v228, v14, v13
    v_fma_f32 v229, v229, v14, v13
    v_fma_f32 v230, v230, v14, v13
    v_fma_f32 v231, v231, v14, v13
    v_fmaak_f32 v14, v200, v200, 0x2b0cbccc
    v_fmac_f32 v14, v201, v201
    v_fmac_f32 v14, v202, v202
    v_mul_f32 v152, v152, v12
    v_mul_f32 v153, v153, v12
    v_mul_f32 v154, v154, v12
    v_mul_f32 v155, v155, v12
    v_mul_f32 v156, v156, v12
    v_mul_f32 v157, v157, v12
    v_mul_f32 v158, v158, v12
    v_mul_f32 v159, v159, v12
    v_mul_f32 v160, v160, v12
    v_mul_f32 v161, v161, v12
    v_mul_f32 v162, v162, v12
    v_mul_f32 v163, v163, v12
    v_fmac_f32 v14, v203, v203
    v_cvt_pk_bf16_f32 v104, v152, v153
    v_cvt_pk_bf16_f32 v105, v154, v155
    v_cvt_pk_bf16_f32 v106, v156, v157
    v_cvt_pk_bf16_f32 v107, v158, v159
    v_cvt_pk_bf16_f32 v108, v160, v161
    v_cvt_pk_bf16_f32 v109, v162, v163
    s_waitcnt lgkmcnt(0)
    v_mfma_f32_32x32x16_bf16 v[136:151], v[104:107], v[88:91], v[136:151]
    v_fmac_f32 v14, v204, v204
    ds_read_b128 v[152:155], v98 offset:192
    ds_read_b128 v[156:159], v98 offset:128
    ds_read_b128 v[160:163], v98 offset:64
    ds_read_b128 v[164:167], v98 offset:0
    v_fmac_f32 v14, v205, v205
    v_mfma_f32_32x32x16_bf16 v[136:151], v[108:111], v[92:95], v[136:151]
    v_fmac_f32 v14, v206, v206
    v_fmac_f32 v14, v207, v207
    v_fmac_f32 v14, v208, v208
    v_fmac_f32 v14, v209, v209
    v_fmac_f32 v14, v210, v210
    v_fmac_f32 v14, v211, v211
    v_mov_b32 v13, v14
    v_cvt_pk_bf16_f32 v216, v216, v217
    v_cvt_pk_bf16_f32 v224, v224, v225
    v_permlane32_swap_b32 v13, v14
    v_add_f32 v14, v13, v14
    v_rsq_f32 v14, v14
    v_cvt_pk_bf16_f32 v217, v218, v219
    v_mul_f32 v200, v200, v14
    v_mul_f32 v201, v201, v14
    v_mul_f32 v202, v202, v14
    v_mul_f32 v203, v203, v14
    v_mul_f32 v204, v204, v14
    v_mul_f32 v205, v205, v14
    v_mul_f32 v206, v206, v14
    v_mul_f32 v207, v207, v14
    v_cvt_pk_bf16_f32 v225, v226, v227
    v_cvt_pk_bf16_f32 v112, v200, v201
    v_cvt_pk_bf16_f32 v113, v202, v203
    v_cvt_pk_bf16_f32 v114, v204, v205
    v_cvt_pk_bf16_f32 v115, v206, v207
    v_cvt_pk_bf16_f32 v218, v220, v221
    v_cvt_pk_bf16_f32 v219, v222, v223
    v_cvt_pk_bf16_f32 v226, v228, v229
    s_waitcnt lgkmcnt(0)
    v_mfma_f32_32x32x16_bf16 v[152:167], v[112:115], v[88:91], v[152:167]
    v_cvt_pk_bf16_f32 v227, v230, v231
    buffer_store_dwordx4 v[216:219], v8, s[20:23], 0 offen offset:0 sc1 nt
    buffer_store_dwordx4 v[224:227], v8, s[20:23], 0 offen offset:64 sc1 nt
    v_mul_f32 v208, v208, v14
    v_mul_f32 v209, v209, v14
    v_mul_f32 v210, v210, v14
    v_mfma_f32_32x32x16_bf16 v[216:231], v[232:235], v[64:67], 0
    v_mul_f32 v211, v211, v14
    v_cvt_pk_bf16_f32 v116, v208, v209
    v_cvt_pk_bf16_f32 v117, v210, v211
    v_max3_f32 v11, v136, v137, v138
    v_max3_f32 v11, v11, v139, v140
    v_max3_f32 v11, v11, v141, v142
    v_mfma_f32_32x32x16_bf16 v[152:167], v[116:119], v[92:95], v[152:167]
    v_max3_f32 v11, v11, v143, v144
    v_max3_f32 v11, v11, v145, v146
    v_max3_f32 v11, v11, v147, v148
    v_max3_f32 v11, v11, v149, v150
    s_mov_b64 exec, s[76:77]
    v_cvt_pk_bf16_f32 v120, v168, v169
    v_cvt_pk_bf16_f32 v121, v170, v171
    v_cvt_pk_bf16_f32 v122, v172, v173
    v_cvt_pk_bf16_f32 v123, v174, v175
    v_cvt_pk_bf16_f32 v124, v176, v177
    v_cvt_pk_bf16_f32 v125, v178, v179
    v_cvt_pk_bf16_f32 v126, v180, v181
    v_cvt_pk_bf16_f32 v127, v182, v183
    s_mov_b64 exec, -1
    v_mfma_f32_32x32x16_bf16 v[216:231], v[236:239], v[68:71], v[216:231]
    v_max3_f32 v11, v11, v151, v152
    v_max3_f32 v11, v11, v153, v154
    v_max3_f32 v11, v11, v155, v156
    v_max3_f32 v11, v11, v157, v158
    v_max3_f32 v11, v11, v159, v160
    v_max3_f32 v11, v11, v161, v162
    v_mfma_f32_32x32x16_bf16 v[216:231], v[240:243], v[72:75], v[216:231]
    v_max3_f32 v11, v11, v163, v164
    v_max3_f32 v11, v11, v165, v166
    v_max_f32 v11, v11, v167
    v_mov_b32 v12, v11
    v_mfma_f32_32x32x16_bf16 v[216:231], v[244:247], v[76:79], v[216:231]
    s_nop 0
    v_permlane32_swap_b32 v11, v12
    v_max_f32 v11, v11, v12
    v_sub_f32 v136, v136, v11
    v_sub_f32 v137, v137, v11
    v_sub_f32 v138, v138, v11
    v_mfma_f32_32x32x16_bf16 v[216:231], v[248:251], v[80:83], v[216:231]
    v_sub_f32 v139, v139, v11
    v_exp_f32 v136, v136
    v_exp_f32 v137, v137
    v_sub_f32 v140, v140, v11
    v_mfma_f32_32x32x16_bf16 v[216:231], v[252:255], v[84:87], v[216:231]
    v_sub_f32 v141, v141, v11
    v_sub_f32 v142, v142, v11
    v_sub_f32 v143, v143, v11
    v_exp_f32 v138, v138
    v_exp_f32 v139, v139
    v_exp_f32 v140, v140
    v_exp_f32 v141, v141
    v_exp_f32 v142, v142
    v_exp_f32 v143, v143
    v_cvt_pk_bf16_f32 v136, v136, v137
    v_cvt_pk_bf16_f32 v137, v138, v139
    v_cvt_pk_bf16_f32 v138, v140, v141
    v_cvt_pk_bf16_f32 v139, v142, v143
    s_mov_b64 exec, s[76:77]
    v_cvt_pk_bf16_f32 v128, v216, v217
    v_cvt_pk_bf16_f32 v129, v218, v219
    v_cvt_pk_bf16_f32 v130, v220, v221
    v_cvt_pk_bf16_f32 v131, v222, v223
    v_cvt_pk_bf16_f32 v132, v224, v225
    v_cvt_pk_bf16_f32 v133, v226, v227
    v_cvt_pk_bf16_f32 v134, v228, v229
    v_cvt_pk_bf16_f32 v135, v230, v231
    s_mov_b64 exec, -1
    v_mfma_f32_32x32x16_bf16 v[168:183], v[120:123], v[136:139], 0
    v_sub_f32 v144, v144, v11
    v_sub_f32 v145, v145, v11
    v_sub_f32 v146, v146, v11
    v_sub_f32 v147, v147, v11
    v_sub_f32 v148, v148, v11
    v_sub_f32 v149, v149, v11
    v_sub_f32 v150, v150, v11
    v_sub_f32 v151, v151, v11
    v_exp_f32 v144, v144
    v_exp_f32 v145, v145
    v_exp_f32 v146, v146
    v_exp_f32 v147, v147
    v_exp_f32 v148, v148
    v_exp_f32 v149, v149
    v_exp_f32 v150, v150
    v_exp_f32 v151, v151
    v_sub_f32 v152, v152, v11
    v_sub_f32 v153, v153, v11
    v_cvt_pk_bf16_f32 v140, v144, v145
    v_cvt_pk_bf16_f32 v141, v146, v147
    v_cvt_pk_bf16_f32 v142, v148, v149
    v_cvt_pk_bf16_f32 v143, v150, v151
    v_sub_f32 v154, v154, v11
    v_sub_f32 v155, v155, v11
    v_mfma_f32_32x32x16_bf16 v[168:183], v[124:127], v[140:143], v[168:183]
    v_exp_f32 v152, v152
    v_exp_f32 v153, v153
    v_sub_f32 v156, v156, v11
    v_sub_f32 v157, v157, v11
    v_sub_f32 v158, v158, v11
    v_sub_f32 v159, v159, v11
    v_exp_f32 v154, v154
    v_exp_f32 v155, v155
    v_exp_f32 v156, v156
    v_exp_f32 v157, v157
    v_exp_f32 v158, v158
    v_exp_f32 v159, v159
    v_cvt_pk_bf16_f32 v152, v152, v153
    v_cvt_pk_bf16_f32 v153, v154, v155
    v_cvt_pk_bf16_f32 v154, v156, v157
    v_cvt_pk_bf16_f32 v155, v158, v159
    v_sub_f32 v160, v160, v11
    v_sub_f32 v161, v161, v11
    v_mfma_f32_32x32x16_bf16 v[168:183], v[128:131], v[152:155], v[168:183]
    v_sub_f32 v162, v162, v11
    v_sub_f32 v163, v163, v11
    v_sub_f32 v164, v164, v11
    v_sub_f32 v165, v165, v11
    v_sub_f32 v166, v166, v11
    v_sub_f32 v167, v167, v11
    v_exp_f32 v160, v160
    v_exp_f32 v161, v161
    v_exp_f32 v162, v162
    v_exp_f32 v163, v163
    v_exp_f32 v164, v164
    v_exp_f32 v165, v165
    v_exp_f32 v166, v166
    v_exp_f32 v167, v167
    v_cvt_pk_bf16_f32 v156, v160, v161
    v_cvt_pk_bf16_f32 v157, v162, v163
    v_cvt_pk_bf16_f32 v158, v164, v165
    v_cvt_pk_bf16_f32 v159, v166, v167
    s_nop 1
    v_mfma_f32_32x32x16_bf16 v[168:183], v[132:135], v[156:159], v[168:183]
    s_nop 11
    v_rcp_f32 v11, v180
    s_nop 0
    v_mul_f32 v168, v168, v11
    v_mul_f32 v169, v169, v11
    v_cvt_pk_bf16_f32 v168, v168, v169
    v_mul_f32 v170, v170, v11
    v_mul_f32 v171, v171, v11
    v_cvt_pk_bf16_f32 v169, v170, v171
    v_mul_f32 v172, v172, v11
    v_mul_f32 v173, v173, v11
    v_cvt_pk_bf16_f32 v170, v172, v173
    v_mul_f32 v174, v174, v11
    v_mul_f32 v175, v175, v11
    v_mul_f32 v176, v176, v11
    v_mul_f32 v177, v177, v11
    v_mul_f32 v178, v178, v11
    v_mul_f32 v179, v179, v11
    v_cvt_pk_bf16_f32 v171, v174, v175
    v_cvt_pk_bf16_f32 v172, v176, v177
    v_cvt_pk_bf16_f32 v173, v178, v179
    ds_write_b128 v4, v[168:171] offset:49152
    ds_write_b64 v5, v[172:173] offset:49152
    s_waitcnt lgkmcnt(0)
    s_nop 1
    s_branch L_slow_RH_ret
.section .rodata,"a"
.p2align 6
.amdhsa_kernel standalone__window_attn_swin_v2__vision_kernel
  .amdhsa_next_free_vgpr 256
  .amdhsa_next_free_sgpr 102
  .amdhsa_accum_offset 256
  .amdhsa_group_segment_fixed_size 0
  .amdhsa_kernarg_size 96
  .amdhsa_user_sgpr_count 2
  .amdhsa_user_sgpr_kernarg_segment_ptr 1
  .amdhsa_system_sgpr_workgroup_id_x 1
  .amdhsa_float_denorm_mode_32 3
.end_amdhsa_kernel
```
